```python
import torch

def _softmax(x, axis=-1):
    return torch.softmax(x, dim=axis)
def _gelu(x):
    return torch.nn.functional.gelu(x, approximate="tanh")
def _silu(x):
    return torch.nn.functional.silu(x)
def _sigmoid(x):
    return torch.sigmoid(x)
def _layernorm(x, axis=-1, eps=1e-5):
    m = x.mean(dim=axis, keepdim=True)
    v = x.var(dim=axis, keepdim=True, unbiased=False)
    return (x - m) / torch.sqrt(v + eps)
def _scatter_add(tgt, idx, src, axis=0):
    return tgt.clone().index_add_(axis, idx, src)
def _segment_sum(src, seg, n):
    out = torch.zeros((n,) + src.shape[1:], dtype=src.dtype)
    return out.index_add_(0, seg, src)
def _pad(x, pw):
    flat = tuple(v for pair in reversed(pw) for v in pair)
    return torch.nn.functional.pad(x, flat)

kernel_name = 'standalone__edge_featured_mpnn_egc__graph'

def setup_inputs():

    _w = (lambda a: (lambda t: t.to(torch.bfloat16) if t.is_floating_point() else t)(torch.as_tensor(a)))
    N, deg, D, De = 10000, 16, 128, max(16, 1)
    E = N * deg
    return {
        "x": _w((lambda *s: torch.randn(*s, dtype=torch.bfloat16) * 0.1)(N, D)),
        "e_attr": _w((lambda *s: torch.randn(*s, dtype=torch.bfloat16) * 0.1)(E, De)),
        "src": _w((lambda lo, hi, *s: torch.randint(lo, hi, s))(0, N, E).to(torch.int64)),
        "dst": _w((lambda lo, hi, *s: torch.randint(lo, hi, s))(0, N, E).to(torch.int64)),
        "u_w": _w((lambda *s: torch.randn(*s, dtype=torch.bfloat16) * 0.05)(D, D)),
        "v_w": _w((lambda *s: torch.randn(*s, dtype=torch.bfloat16) * 0.05)(D, D)),
        "g_w": _w((lambda *s: torch.randn(*s, dtype=torch.bfloat16) * 0.1)(2 * D + De, D)),
    }

def reference(x, e_attr, src, dst, u_w, v_w, g_w):
    N, D = x.shape
    g_in = torch.concatenate([x[dst], x[src], e_attr], axis=-1)
    eta = _sigmoid(g_in @ g_w)
    hv = x @ v_w
    msg = eta * hv[src]
    agg = _segment_sum(msg, dst, N)
    return _silu(x @ u_w + agg)
```

```asm
; @launch kernel=prep_kernel grid=(256,1,1) block=(512,1,1) lds=99328
; @launch kernel=standalone__edge_featured_mpnn_egc__graph_kernel grid=(256,1,1) block=(1024,1,1) lds=146112
.amdgcn_target "amdgcn-amd-amdhsa--gfx950"
.text
.globl prep_kernel
.p2align 8
.type prep_kernel,@function
prep_kernel:
    s_cmp_ge_u32 s2, 256
    s_cbranch_scc1 K1_END
    s_load_dwordx16 s[4:19], s[0:1], 0
    s_load_dwordx2 s[20:21], s[0:1], 72
    s_cmp_ge_u32 s2, 222
    s_cbranch_scc1 K1_WARM
    s_cmp_ge_u32 s2, 64
    s_cbranch_scc1 K1_GEMM
    v_lshlrev_b32 v1, 2, v0
    s_mul_i32 s22, s2, 10000
    v_mov_b32 v20, -1
    v_mov_b32 v21, -1
    v_mov_b32 v22, -1
    v_mov_b32 v23, -1
    v_lshlrev_b32 v2, 4, v0
    v_mov_b32 v24, 0
    s_waitcnt lgkmcnt(0)
    s_mov_b32 s24, s8
    s_mov_b32 s25, s9
    s_mov_b32 s26, 0x9c400
    s_mov_b32 s27, 0x00020000
    s_mov_b32 s28, s10
    s_mov_b32 s29, s11
    s_mov_b32 s30, 0x9c400
    s_mov_b32 s31, 0x00020000
    s_mov_b32 s32, s20
    s_mov_b32 s33, s21
    s_mov_b32 s34, 0x200000
    s_mov_b32 s35, 0x00020000
    s_add_u32 s23, s22, 0
    buffer_load_dword v4, v1, s[28:31], s23 offen
    buffer_load_dword v10, v1, s[24:27], s23 offen
    s_add_u32 s23, s22, 2048
    buffer_load_dword v5, v1, s[28:31], s23 offen
    buffer_load_dword v11, v1, s[24:27], s23 offen
    s_add_u32 s23, s22, 4096
    buffer_load_dword v6, v1, s[28:31], s23 offen
    buffer_load_dword v12, v1, s[24:27], s23 offen
    s_add_u32 s23, s22, 6144
    buffer_load_dword v7, v1, s[28:31], s23 offen
    buffer_load_dword v13, v1, s[24:27], s23 offen
    s_add_u32 s23, s22, 8192
    buffer_load_dword v8, v1, s[28:31], s23 offen
    buffer_load_dword v14, v1, s[24:27], s23 offen
    v_lshlrev_b32 v19, 2, v1
    ds_write_b128 v2, v[20:23] offset:0
    ds_write_b128 v2, v[20:23] offset:8192
    ds_write_b128 v2, v[20:23] offset:16384
    ds_write_b128 v2, v[20:23] offset:24576
    ds_write_b32 v1, v24 offset:32768
    v_mov_b32 v25, 0x10000
    s_movk_i32 s38, 5000
    s_waitcnt lgkmcnt(0)
    s_barrier
    s_movk_i32 s23, 452
    v_cmp_gt_u32 s[36:37], s23, v0
    s_waitcnt vmcnt(8)
    v_cmp_le_u32 s[40:41], s38, v10
    v_and_b32 v26, 0xff, v4
    v_lshlrev_b32 v16, 2, v26
    v_cndmask_b32 v17, 1, v25, s[40:41]
    ds_add_rtn_u32 v32, v16, v17 offset:32768
    s_waitcnt vmcnt(6)
    v_cmp_le_u32 s[42:43], s38, v11
    v_and_b32 v27, 0xff, v5
    v_lshlrev_b32 v16, 2, v27
    v_cndmask_b32 v17, 1, v25, s[42:43]
    ds_add_rtn_u32 v33, v16, v17 offset:32768
    s_waitcnt vmcnt(4)
    v_cmp_le_u32 s[44:45], s38, v12
    v_and_b32 v28, 0xff, v6
    v_lshlrev_b32 v16, 2, v28
    v_cndmask_b32 v17, 1, v25, s[44:45]
    ds_add_rtn_u32 v34, v16, v17 offset:32768
    s_waitcnt vmcnt(2)
    v_cmp_le_u32 s[46:47], s38, v13
    v_and_b32 v29, 0xff, v7
    v_lshlrev_b32 v16, 2, v29
    v_cndmask_b32 v17, 1, v25, s[46:47]
    ds_add_rtn_u32 v35, v16, v17 offset:32768
    s_waitcnt vmcnt(0)
    v_cmp_le_u32 s[48:49], s38, v14
    s_mov_b64 exec, s[36:37]
    v_and_b32 v30, 0xff, v8
    v_lshlrev_b32 v16, 2, v30
    v_cndmask_b32 v17, 1, v25, s[48:49]
    ds_add_rtn_u32 v36, v16, v17 offset:32768
    s_mov_b64 exec, -1
    s_waitcnt vmcnt(0)
    v_lshrrev_b32 v4, 8, v4
    v_lshl_or_b32 v4, v10, 6, v4
    v_add_u32 v16, 0, v0
    v_lshl_or_b32 v4, v16, 20, v4
    v_lshrrev_b32 v5, 8, v5
    v_lshl_or_b32 v5, v11, 6, v5
    v_add_u32 v16, 512, v0
    v_lshl_or_b32 v5, v16, 20, v5
    v_lshrrev_b32 v6, 8, v6
    v_lshl_or_b32 v6, v12, 6, v6
    v_add_u32 v16, 1024, v0
    v_lshl_or_b32 v6, v16, 20, v6
    v_lshrrev_b32 v7, 8, v7
    v_lshl_or_b32 v7, v13, 6, v7
    v_add_u32 v16, 1536, v0
    v_lshl_or_b32 v7, v16, 20, v7
    v_lshrrev_b32 v8, 8, v8
    v_lshl_or_b32 v8, v14, 6, v8
    v_add_u32 v16, 2048, v0
    v_lshl_or_b32 v8, v16, 20, v8
    s_waitcnt lgkmcnt(4)
    v_and_b32 v16, 0xffff, v32
    v_lshrrev_b32 v17, 16, v32
    v_sub_u32 v17, 31, v17
    v_cndmask_b32 v16, v16, v17, s[40:41]
    v_cmp_gt_u32 vcc, 32, v16
    v_lshlrev_b32 v16, 2, v16
    v_lshl_add_u32 v38, v26, 7, v16
    s_mov_b64 s[40:41], vcc
    s_waitcnt lgkmcnt(3)
    v_and_b32 v16, 0xffff, v33
    v_lshrrev_b32 v17, 16, v33
    v_sub_u32 v17, 31, v17
    v_cndmask_b32 v16, v16, v17, s[42:43]
    v_cmp_gt_u32 vcc, 32, v16
    v_lshlrev_b32 v16, 2, v16
    v_lshl_add_u32 v39, v27, 7, v16
    s_mov_b64 s[42:43], vcc
    s_waitcnt lgkmcnt(2)
    v_and_b32 v16, 0xffff, v34
    v_lshrrev_b32 v17, 16, v34
    v_sub_u32 v17, 31, v17
    v_cndmask_b32 v16, v16, v17, s[44:45]
    v_cmp_gt_u32 vcc, 32, v16
    v_lshlrev_b32 v16, 2, v16
    v_lshl_add_u32 v40, v28, 7, v16
    s_mov_b64 s[44:45], vcc
    s_waitcnt lgkmcnt(1)
    v_and_b32 v16, 0xffff, v35
    v_lshrrev_b32 v17, 16, v35
    v_sub_u32 v17, 31, v17
    v_cndmask_b32 v16, v16, v17, s[46:47]
    v_cmp_gt_u32 vcc, 32, v16
    v_lshlrev_b32 v16, 2, v16
    v_lshl_add_u32 v41, v29, 7, v16
    s_mov_b64 s[46:47], vcc
    s_waitcnt lgkmcnt(0)
    v_and_b32 v16, 0xffff, v36
    v_lshrrev_b32 v17, 16, v36
    v_sub_u32 v17, 31, v17
    v_cndmask_b32 v16, v16, v17, s[48:49]
    v_cmp_gt_u32 vcc, 32, v16
    v_lshlrev_b32 v16, 2, v16
    v_lshl_add_u32 v42, v30, 7, v16
    s_and_b64 vcc, vcc, s[36:37]
    s_mov_b64 s[48:49], vcc
    s_mov_b64 exec, s[40:41]
    ds_write_b32 v38, v4
    s_mov_b64 exec, s[42:43]
    ds_write_b32 v39, v5
    s_mov_b64 exec, s[44:45]
    ds_write_b32 v40, v6
    s_mov_b64 exec, s[46:47]
    ds_write_b32 v41, v7
    s_mov_b64 exec, s[48:49]
    ds_write_b32 v42, v8
    s_mov_b64 exec, -1
    s_waitcnt lgkmcnt(0)
    s_barrier
    v_lshrrev_b32 v3, 3, v0
    v_lshlrev_b32 v16, 2, v3
    ds_read_b128 v[44:47], v2 offset:0
    ds_read_b32 v60, v16 offset:32768
    ds_read_b128 v[48:51], v2 offset:8192
    ds_read_b32 v61, v16 offset:33024
    ds_read_b128 v[52:55], v2 offset:16384
    ds_read_b32 v62, v16 offset:33280
    ds_read_b128 v[56:59], v2 offset:24576
    ds_read_b32 v63, v16 offset:33536
    v_and_b32 v17, 7, v0
    v_cmp_eq_u32 vcc, 0, v17
    v_lshlrev_b32 v17, 4, v17
    v_lshl_add_u32 v17, v3, 13, v17
    v_mov_b32 v18, -2
    v_cndmask_b32 v18, -1, v18, vcc
    s_lshl_b32 s22, s2, 7
    s_waitcnt lgkmcnt(6)
    v_add_u32_sdwa v60, v60, v60 dst_sel:DWORD dst_unused:UNUSED_PAD src0_sel:WORD_0 src1_sel:WORD_1
    v_cmp_lt_u32 vcc, 32, v60
    s_add_u32 s23, s22, 0
    s_nop 0
    v_cndmask_b32 v44, v44, v18, vcc
    v_cndmask_b32 v45, v45, v20, vcc
    v_cndmask_b32 v46, v46, v20, vcc
    v_cndmask_b32 v47, v47, v20, vcc
    buffer_store_dwordx4 v[44:47], v17, s[32:35], s23 offen sc1
    s_waitcnt lgkmcnt(4)
    v_add_u32_sdwa v61, v61, v61 dst_sel:DWORD dst_unused:UNUSED_PAD src0_sel:WORD_0 src1_sel:WORD_1
    v_cmp_lt_u32 vcc, 32, v61
    s_add_u32 s23, s22, 524288
    s_nop 0
    v_cndmask_b32 v48, v48, v18, vcc
    v_cndmask_b32 v49, v49, v20, vcc
    v_cndmask_b32 v50, v50, v20, vcc
    v_cndmask_b32 v51, v51, v20, vcc
    buffer_store_dwordx4 v[48:51], v17, s[32:35], s23 offen sc1
    s_waitcnt lgkmcnt(2)
    v_add_u32_sdwa v62, v62, v62 dst_sel:DWORD dst_unused:UNUSED_PAD src0_sel:WORD_0 src1_sel:WORD_1
    v_cmp_lt_u32 vcc, 32, v62
    s_add_u32 s23, s22, 1048576
    s_nop 0
    v_cndmask_b32 v52, v52, v18, vcc
    v_cndmask_b32 v53, v53, v20, vcc
    v_cndmask_b32 v54, v54, v20, vcc
    v_cndmask_b32 v55, v55, v20, vcc
    buffer_store_dwordx4 v[52:55], v17, s[32:35], s23 offen sc1
    s_waitcnt lgkmcnt(0)
    v_add_u32_sdwa v63, v63, v63 dst_sel:DWORD dst_unused:UNUSED_PAD src0_sel:WORD_0 src1_sel:WORD_1
    v_cmp_lt_u32 vcc, 32, v63
    s_add_u32 s23, s22, 1572864
    s_nop 0
    v_cndmask_b32 v56, v56, v18, vcc
    v_cndmask_b32 v57, v57, v20, vcc
    v_cndmask_b32 v58, v58, v20, vcc
    v_cndmask_b32 v59, v59, v20, vcc
    buffer_store_dwordx4 v[56:59], v17, s[32:35], s23 offen sc1
    v_readfirstlane_b32 s52, v0
    s_cmp_lg_u32 s52, 0
    s_cbranch_scc1 K1_TP
    s_mov_b32 s48, s6
    s_mov_b32 s49, s7
    s_mov_b32 s50, 0x4e2000
    s_mov_b32 s51, 0x00020000
    v_mul_u32_u24 v110, 80000, v0
    buffer_load_dword v111, v110, s[48:51], 0 offen
    s_mov_b32 s48, s18
    s_mov_b32 s49, s19
    s_mov_b32 s50, 0x271000
    s_mov_b32 s51, 0x00020000
    v_lshrrev_b32 v110, 1, v110
    buffer_load_dword v111, v110, s[48:51], 0 offen
K1_TP:
    s_endpgm
K1_GEMM:
    s_sub_u32 s3, s2, 64
    v_lshlrev_b32 v1, 4, v0
    v_lshrrev_b32 v2, 4, v0
    v_mul_u32_u24 v2, 320, v2
    v_and_b32 v3, 15, v0
    v_lshl_add_u32 v2, v3, 4, v2
    v_lshrrev_b32 v4, 6, v0
    v_and_b32 v5, 63, v0
    v_readfirstlane_b32 s36, v4
    s_waitcnt lgkmcnt(0)
    s_cmp_eq_u32 s3, 157
    s_cselect_b32 s22, 0, 32768
    s_cselect_b32 s28, s12, s14
    s_cselect_b32 s29, s13, s15
    s_mov_b32 s30, 32768
    s_mov_b32 s31, 0x00020000
    s_mov_b32 s24, s16
    s_mov_b32 s25, s17
    s_mov_b32 s26, 0x11000
    s_mov_b32 s27, 0x00020000
    s_mov_b32 s32, s4
    s_mov_b32 s33, s5
    s_mov_b32 s34, 0x271000
    s_mov_b32 s35, 0x00020000
    s_lshr_b32 s37, s36, 2
    s_and_b32 s38, s36, 3
    s_lshl_b32 s39, s3, 1
    s_add_u32 s39, s39, s37
    s_lshl_b32 s40, s3, 14
    v_and_b32 v6, 31, v5
    v_lshrrev_b32 v7, 5, v5
    s_add_u32 s41, s40, 8192
    buffer_load_dwordx4 v[48:51], v1, s[32:35], s40 offen
    buffer_load_dwordx4 v[52:55], v1, s[32:35], s41 offen
    s_add_u32 s23, s22, 0
    buffer_load_dwordx4 v[16:19], v1, s[24:27], s23 offen
    s_add_u32 s23, s22, 8192
    buffer_load_dwordx4 v[20:23], v1, s[24:27], s23 offen
    s_add_u32 s23, s22, 16384
    buffer_load_dwordx4 v[24:27], v1, s[24:27], s23 offen
    s_add_u32 s23, s22, 24576
    buffer_load_dwordx4 v[28:31], v1, s[24:27], s23 offen
    s_mov_b32 s23, 0
    buffer_load_dwordx4 v[32:35], v1, s[28:31], s23 offen
    s_mov_b32 s23, 8192
    buffer_load_dwordx4 v[36:39], v1, s[28:31], s23 offen
    s_mov_b32 s23, 16384
    buffer_load_dwordx4 v[40:43], v1, s[28:31], s23 offen
    s_mov_b32 s23, 24576
    buffer_load_dwordx4 v[44:47], v1, s[28:31], s23 offen
    v_lshrrev_b32 v12, 4, v0
    v_mul_u32_u24 v12, 272, v12
    v_lshl_add_u32 v12, v3, 4, v12
    v_add_u32 v12, 81920, v12
    s_lshl_b32 s41, s37, 5
    v_add_u32 v8, s41, v6
    v_mul_u32_u24 v8, 272, v8
    v_lshl_add_u32 v8, v7, 4, v8
    v_add_u32 v8, 81920, v8
    v_bfe_u32 v9, v5, 2, 2
    v_lshl_add_u32 v9, v7, 3, v9
    v_mul_u32_u24 v9, 320, v9
    v_bfe_u32 v10, v5, 4, 1
    v_lshl_add_u32 v9, v10, 5, v9
    v_and_b32 v10, 3, v5
    v_lshl_add_u32 v9, v10, 3, v9
    s_lshl_b32 s41, s38, 6
    v_add_u32 v9, s41, v9
    v_add_u32 v10, 40960, v9
    v_add_u32 v11, 40960, v2
    s_waitcnt vmcnt(9)
    ds_write_b128 v12, v[48:51]
    s_waitcnt vmcnt(8)
    ds_write_b128 v12, v[52:55] offset:8704
    s_waitcnt vmcnt(7)
    ds_write_b128 v2, v[16:19] offset:0
    s_waitcnt vmcnt(6)
    ds_write_b128 v2, v[20:23] offset:10240
    s_waitcnt vmcnt(5)
    ds_write_b128 v2, v[24:27] offset:20480
    s_waitcnt vmcnt(4)
    ds_write_b128 v2, v[28:31] offset:30720
    s_waitcnt lgkmcnt(0)
    s_barrier
    ds_read_b128 v[48:51], v8 offset:0
    ds_read_b64_tr_b16 v[80:81], v9 offset:0
    ds_read_b64_tr_b16 v[82:83], v9 offset:1280
    ds_read_b128 v[52:55], v8 offset:32
    ds_read_b64_tr_b16 v[84:85], v9 offset:5120
    ds_read_b64_tr_b16 v[86:87], v9 offset:6400
    ds_read_b128 v[56:59], v8 offset:64
    ds_read_b64_tr_b16 v[88:89], v9 offset:10240
    ds_read_b64_tr_b16 v[90:91], v9 offset:11520
    ds_read_b128 v[60:63], v8 offset:96
    ds_read_b64_tr_b16 v[92:93], v9 offset:15360
    ds_read_b64_tr_b16 v[94:95], v9 offset:16640
    s_waitcnt lgkmcnt(9)
    v_mfma_f32_32x32x16_bf16 v[16:31], v[48:51], v[80:83], 0
    ds_read_b128 v[64:67], v8 offset:128
    ds_read_b64_tr_b16 v[96:97], v9 offset:20480
    ds_read_b64_tr_b16 v[98:99], v9 offset:21760
    s_waitcnt lgkmcnt(9)
    v_mfma_f32_32x32x16_bf16 v[16:31], v[52:55], v[84:87], v[16:31]
    ds_read_b128 v[68:71], v8 offset:160
    ds_read_b64_tr_b16 v[100:101], v9 offset:25600
    ds_read_b64_tr_b16 v[102:103], v9 offset:26880
    s_waitcnt lgkmcnt(9)
    v_mfma_f32_32x32x16_bf16 v[16:31], v[56:59], v[88:91], v[16:31]
    ds_read_b128 v[72:75], v8 offset:192
    ds_read_b64_tr_b16 v[104:105], v9 offset:30720
    ds_read_b64_tr_b16 v[106:107], v9 offset:32000
    s_waitcnt lgkmcnt(9)
    v_mfma_f32_32x32x16_bf16 v[16:31], v[60:63], v[92:95], v[16:31]
    ds_read_b128 v[76:79], v8 offset:224
    ds_read_b64_tr_b16 v[108:109], v9 offset:35840
    ds_read_b64_tr_b16 v[110:111], v9 offset:37120
    s_waitcnt lgkmcnt(9)
    v_mfma_f32_32x32x16_bf16 v[16:31], v[64:67], v[96:99], v[16:31]
    s_waitcnt lgkmcnt(6)
    v_mfma_f32_32x32x16_bf16 v[16:31], v[68:71], v[100:103], v[16:31]
    s_waitcnt lgkmcnt(3)
    v_mfma_f32_32x32x16_bf16 v[16:31], v[72:75], v[104:107], v[16:31]
    s_waitcnt lgkmcnt(0)
    v_mfma_f32_32x32x16_bf16 v[16:31], v[76:79], v[108:111], v[16:31]
    s_waitcnt vmcnt(3)
    ds_write_b128 v11, v[32:35] offset:0
    s_waitcnt vmcnt(2)
    ds_write_b128 v11, v[36:39] offset:10240
    s_waitcnt vmcnt(1)
    ds_write_b128 v11, v[40:43] offset:20480
    s_waitcnt vmcnt(0)
    ds_write_b128 v11, v[44:47] offset:30720
    s_add_u32 s44, s20, 0x200000
    s_addc_u32 s45, s21, 0
    s_mov_b32 s46, 0x4e2000
    s_mov_b32 s47, 0x00020000
    s_lshl_b32 s40, s39, 14
    s_lshl_b32 s41, s38, 7
    s_add_u32 s40, s40, s41
    s_mov_b32 s42, 0xbfb8aa3b
    s_mov_b32 s43, 0xffff0000
    v_readfirstlane_b32 s52, v0
    s_cmp_lg_u32 s52, 0
    s_cbranch_scc1 K1_TG
    s_mov_b32 s48, s6
    s_mov_b32 s49, s7
    s_mov_b32 s50, 0x4e2000
    s_mov_b32 s51, 0x00020000
    v_mul_u32_u24 v13, 80000, v0
    buffer_load_dword v14, v13, s[48:51], 0 offen
    s_mov_b32 s48, s18
    s_mov_b32 s49, s19
    s_mov_b32 s50, 0x271000
    s_mov_b32 s51, 0x00020000
    v_lshrrev_b32 v13, 1, v13
    buffer_load_dword v14, v13, s[48:51], 0 offen
    s_mov_b64 exec, 1
    buffer_load_dword v14, v13, s[44:47], s40 offen
    s_mov_b64 exec, -1
K1_TG:
    s_mov_b32 s48, s6
    s_mov_b32 s49, s7
    s_mov_b32 s50, 0x4e2000
    s_mov_b32 s51, 0x00020000
    s_mul_i32 s52, s3, 8192
    v_lshlrev_b32 v175, 4, v0
    buffer_load_dwordx4 v[160:163], v175, s[48:51], s52 offen
    s_add_u32 s52, s52, 8192
    s_waitcnt lgkmcnt(0)
    s_barrier
    ds_read_b64_tr_b16 v[112:113], v10 offset:0
    ds_read_b64_tr_b16 v[114:115], v10 offset:1280
    ds_read_b64_tr_b16 v[116:117], v10 offset:5120
    ds_read_b64_tr_b16 v[118:119], v10 offset:6400
    ds_read_b64_tr_b16 v[120:121], v10 offset:10240
    ds_read_b64_tr_b16 v[122:123], v10 offset:11520
    ds_read_b64_tr_b16 v[124:125], v10 offset:15360
    ds_read_b64_tr_b16 v[126:127], v10 offset:16640
    s_waitcnt lgkmcnt(6)
    v_mfma_f32_32x32x16_bf16 v[144:159], v[48:51], v[112:115], 0
    v_mul_f32 v16, s42, v16
    v_mul_f32 v17, s42, v17
    ds_read_b64_tr_b16 v[128:129], v10 offset:20480
    ds_read_b64_tr_b16 v[130:131], v10 offset:21760
    s_waitcnt lgkmcnt(6)
    v_mfma_f32_32x32x16_bf16 v[144:159], v[52:55], v[116:119], v[144:159]
    v_mul_f32 v18, s42, v18
    v_mul_f32 v19, s42, v19
    ds_read_b64_tr_b16 v[132:133], v10 offset:25600
    ds_read_b64_tr_b16 v[134:135], v10 offset:26880
    s_waitcnt lgkmcnt(6)
    v_mfma_f32_32x32x16_bf16 v[144:159], v[56:59], v[120:123], v[144:159]
    v_mul_f32 v20, s42, v20
    v_mul_f32 v21, s42, v21
    ds_read_b64_tr_b16 v[136:137], v10 offset:30720
    ds_read_b64_tr_b16 v[138:139], v10 offset:32000
    s_waitcnt lgkmcnt(6)
    v_mfma_f32_32x32x16_bf16 v[144:159], v[60:63], v[124:127], v[144:159]
    v_mul_f32 v22, s42, v22
    v_mul_f32 v23, s42, v23
    ds_read_b64_tr_b16 v[140:141], v10 offset:35840
    ds_read_b64_tr_b16 v[142:143], v10 offset:37120
    s_waitcnt lgkmcnt(6)
    v_mfma_f32_32x32x16_bf16 v[144:159], v[64:67], v[128:131], v[144:159]
    v_mul_f32 v24, s42, v24
    v_mul_f32 v25, s42, v25
    s_waitcnt lgkmcnt(4)
    v_mfma_f32_32x32x16_bf16 v[144:159], v[68:71], v[132:135], v[144:159]
    v_mul_f32 v26, s42, v26
    v_mul_f32 v27, s42, v27
    s_waitcnt lgkmcnt(2)
    v_mfma_f32_32x32x16_bf16 v[144:159], v[72:75], v[136:139], v[144:159]
    v_mul_f32 v28, s42, v28
    v_mul_f32 v29, s42, v29
    s_waitcnt lgkmcnt(0)
    v_mfma_f32_32x32x16_bf16 v[144:159], v[76:79], v[140:143], v[144:159]
    v_mul_f32 v30, s42, v30
    v_mul_f32 v31, s42, v31
    s_cmp_eq_u32 s3, 157
    s_cbranch_scc1 K1_PACK
    v_lshlrev_b32 v8, 11, v7
    v_lshl_add_u32 v8, v6, 2, v8
    s_nop 5
    v_cvt_pk_bf16_f32 v32, v16, v144
    v_and_b32 v33, s43, v32
    v_sub_f32 v32, v33, v32
    v_add_f32 v144, v144, v32
    v_cvt_pk_bf16_f32 v144, v16, v144
    s_add_u32 s41, s40, 0
    buffer_store_dword v144, v8, s[44:47], s41 offen offset:0 sc1
    v_cvt_pk_bf16_f32 v34, v17, v145
    v_and_b32 v35, s43, v34
    v_sub_f32 v34, v35, v34
    v_add_f32 v145, v145, v34
    v_cvt_pk_bf16_f32 v145, v17, v145
    buffer_store_dword v145, v8, s[44:47], s41 offen offset:512 sc1
    v_cvt_pk_bf16_f32 v36, v18, v146
    v_and_b32 v37, s43, v36
    v_sub_f32 v36, v37, v36
    v_add_f32 v146, v146, v36
    v_cvt_pk_bf16_f32 v146, v18, v146
    buffer_store_dword v146, v8, s[44:47], s41 offen offset:1024 sc1
    v_cvt_pk_bf16_f32 v38, v19, v147
    v_and_b32 v39, s43, v38
    v_sub_f32 v38, v39, v38
    v_add_f32 v147, v147, v38
    v_cvt_pk_bf16_f32 v147, v19, v147
    buffer_store_dword v147, v8, s[44:47], s41 offen offset:1536 sc1
    v_cvt_pk_bf16_f32 v32, v20, v148
    v_and_b32 v33, s43, v32
    v_sub_f32 v32, v33, v32
    v_add_f32 v148, v148, v32
    v_cvt_pk_bf16_f32 v148, v20, v148
    s_add_u32 s41, s40, 4096
    buffer_store_dword v148, v8, s[44:47], s41 offen offset:0 sc1
    v_cvt_pk_bf16_f32 v34, v21, v149
    v_and_b32 v35, s43, v34
    v_sub_f32 v34, v35, v34
    v_add_f32 v149, v149, v34
    v_cvt_pk_bf16_f32 v149, v21, v149
    buffer_store_dword v149, v8, s[44:47], s41 offen offset:512 sc1
    v_cvt_pk_bf16_f32 v36, v22, v150
    v_and_b32 v37, s43, v36
    v_sub_f32 v36, v37, v36
    v_add_f32 v150, v150, v36
    v_cvt_pk_bf16_f32 v150, v22, v150
    buffer_store_dword v150, v8, s[44:47], s41 offen offset:1024 sc1
    v_cvt_pk_bf16_f32 v38, v23, v151
    v_and_b32 v39, s43, v38
    v_sub_f32 v38, v39, v38
    v_add_f32 v151, v151, v38
    v_cvt_pk_bf16_f32 v151, v23, v151
    buffer_store_dword v151, v8, s[44:47], s41 offen offset:1536 sc1
    v_cvt_pk_bf16_f32 v32, v24, v152
    v_and_b32 v33, s43, v32
    v_sub_f32 v32, v33, v32
    v_add_f32 v152, v152, v32
    v_cvt_pk_bf16_f32 v152, v24, v152
    s_add_u32 s41, s40, 8192
    buffer_store_dword v152, v8, s[44:47], s41 offen offset:0 sc1
    v_cvt_pk_bf16_f32 v34, v25, v153
    v_and_b32 v35, s43, v34
    v_sub_f32 v34, v35, v34
    v_add_f32 v153, v153, v34
    v_cvt_pk_bf16_f32 v153, v25, v153
    buffer_store_dword v153, v8, s[44:47], s41 offen offset:512 sc1
    v_cvt_pk_bf16_f32 v36, v26, v154
    v_and_b32 v37, s43, v36
    v_sub_f32 v36, v37, v36
    v_add_f32 v154, v154, v36
    v_cvt_pk_bf16_f32 v154, v26, v154
    buffer_store_dword v154, v8, s[44:47], s41 offen offset:1024 sc1
    v_cvt_pk_bf16_f32 v38, v27, v155
    v_and_b32 v39, s43, v38
    v_sub_f32 v38, v39, v38
    v_add_f32 v155, v155, v38
    v_cvt_pk_bf16_f32 v155, v27, v155
    buffer_store_dword v155, v8, s[44:47], s41 offen offset:1536 sc1
    v_cvt_pk_bf16_f32 v32, v28, v156
    v_and_b32 v33, s43, v32
    v_sub_f32 v32, v33, v32
    v_add_f32 v156, v156, v32
    v_cvt_pk_bf16_f32 v156, v28, v156
    s_add_u32 s41, s40, 12288
    buffer_store_dword v156, v8, s[44:47], s41 offen offset:0 sc1
    v_cvt_pk_bf16_f32 v34, v29, v157
    v_and_b32 v35, s43, v34
    v_sub_f32 v34, v35, v34
    v_add_f32 v157, v157, v34
    v_cvt_pk_bf16_f32 v157, v29, v157
    buffer_store_dword v157, v8, s[44:47], s41 offen offset:512 sc1
    v_cvt_pk_bf16_f32 v36, v30, v158
    v_and_b32 v37, s43, v36
    v_sub_f32 v36, v37, v36
    v_add_f32 v158, v158, v36
    v_cvt_pk_bf16_f32 v158, v30, v158
    buffer_store_dword v158, v8, s[44:47], s41 offen offset:1024 sc1
    v_cvt_pk_bf16_f32 v38, v31, v159
    v_and_b32 v39, s43, v38
    v_sub_f32 v38, v39, v38
    v_add_f32 v159, v159, v38
    v_cvt_pk_bf16_f32 v159, v31, v159
    buffer_store_dword v159, v8, s[44:47], s41 offen offset:1536 sc1
    s_endpgm
K1_PACK:
    s_add_u32 s28, s20, 0x800000
    s_addc_u32 s29, s21, 0
    s_mov_b32 s30, 0x11000
    s_mov_b32 s31, 0x00020000
    v_lshlrev_b32 v8, 4, v5
    s_cmp_eq_u32 s37, 0
    s_cbranch_scc0 K1_PACKC
    s_lshl_b32 s40, s38, 13
    s_add_u32 s41, s40, 0
    s_add_u32 s42, s40, 32768
    buffer_store_dwordx4 v[80:83], v8, s[28:31], s41 offen offset:0 sc1
    buffer_store_dwordx4 v[112:115], v8, s[28:31], s42 offen offset:0 sc1
    buffer_store_dwordx4 v[84:87], v8, s[28:31], s41 offen offset:1024 sc1
    buffer_store_dwordx4 v[116:119], v8, s[28:31], s42 offen offset:1024 sc1
    buffer_store_dwordx4 v[88:91], v8, s[28:31], s41 offen offset:2048 sc1
    buffer_store_dwordx4 v[120:123], v8, s[28:31], s42 offen offset:2048 sc1
    buffer_store_dwordx4 v[92:95], v8, s[28:31], s41 offen offset:3072 sc1
    buffer_store_dwordx4 v[124:127], v8, s[28:31], s42 offen offset:3072 sc1
    s_add_u32 s41, s40, 4096
    s_add_u32 s42, s40, 36864
    buffer_store_dwordx4 v[96:99], v8, s[28:31], s41 offen offset:0 sc1
    buffer_store_dwordx4 v[128:131], v8, s[28:31], s42 offen offset:0 sc1
    buffer_store_dwordx4 v[100:103], v8, s[28:31], s41 offen offset:1024 sc1
    buffer_store_dwordx4 v[132:135], v8, s[28:31], s42 offen offset:1024 sc1
    buffer_store_dwordx4 v[104:107], v8, s[28:31], s41 offen offset:2048 sc1
    buffer_store_dwordx4 v[136:139], v8, s[28:31], s42 offen offset:2048 sc1
    buffer_store_dwordx4 v[108:111], v8, s[28:31], s41 offen offset:3072 sc1
    buffer_store_dwordx4 v[140:143], v8, s[28:31], s42 offen offset:3072 sc1
    s_endpgm
K1_PACKC:
    v_lshlrev_b32 v12, 11, v7
    v_lshl_add_u32 v12, v6, 1, v12
    s_lshl_b32 s40, s38, 6
    s_add_u32 s40, s40, 65536
    buffer_load_ushort v16, v12, s[24:27], s40 offen offset:0
    buffer_load_ushort v17, v12, s[24:27], s40 offen offset:256
    buffer_load_ushort v18, v12, s[24:27], s40 offen offset:512
    buffer_load_ushort v19, v12, s[24:27], s40 offen offset:768
    buffer_load_ushort v20, v12, s[24:27], s40 offen offset:1024
    buffer_load_ushort v21, v12, s[24:27], s40 offen offset:1280
    buffer_load_ushort v22, v12, s[24:27], s40 offen offset:1536
    buffer_load_ushort v23, v12, s[24:27], s40 offen offset:1792
    s_mov_b32 s42, 0xbfb8aa3b
    s_waitcnt vmcnt(0)
    v_lshlrev_b32 v16, 16, v16
    v_mul_f32 v16, s42, v16
    v_lshlrev_b32 v17, 16, v17
    v_mul_f32 v17, s42, v17
    v_lshlrev_b32 v18, 16, v18
    v_mul_f32 v18, s42, v18
    v_lshlrev_b32 v19, 16, v19
    v_mul_f32 v19, s42, v19
    v_lshlrev_b32 v20, 16, v20
    v_mul_f32 v20, s42, v20
    v_lshlrev_b32 v21, 16, v21
    v_mul_f32 v21, s42, v21
    v_lshlrev_b32 v22, 16, v22
    v_mul_f32 v22, s42, v22
    v_lshlrev_b32 v23, 16, v23
    v_mul_f32 v23, s42, v23
    v_cvt_pk_bf16_f32 v24, v16, v17
    v_cvt_pk_bf16_f32 v25, v18, v19
    v_cvt_pk_bf16_f32 v26, v20, v21
    v_cvt_pk_bf16_f32 v27, v22, v23
    s_lshl_b32 s40, s38, 10
    s_add_u32 s40, s40, 65536
    buffer_store_dwordx4 v[24:27], v8, s[28:31], s40 offen sc1
    s_endpgm
K1_WARM:
    v_lshlrev_b32 v2, 4, v0
    s_sub_u32 s3, s2, 222
    s_mul_i32 s52, s3, 114688
    s_add_u32 s52, s52, 1294336
    s_waitcnt lgkmcnt(0)
    s_mov_b32 s48, s6
    s_mov_b32 s49, s7
    s_mov_b32 s50, 0x4e2000
    s_mov_b32 s51, 0x00020000
    buffer_load_dwordx4 v[16:19], v2, s[48:51], s52 offen
    s_add_u32 s52, s52, 8192
    buffer_load_dwordx4 v[20:23], v2, s[48:51], s52 offen
    s_add_u32 s52, s52, 8192
    buffer_load_dwordx4 v[24:27], v2, s[48:51], s52 offen
    s_add_u32 s52, s52, 8192
    buffer_load_dwordx4 v[28:31], v2, s[48:51], s52 offen
    s_add_u32 s52, s52, 8192
    buffer_load_dwordx4 v[32:35], v2, s[48:51], s52 offen
    s_add_u32 s52, s52, 8192
    buffer_load_dwordx4 v[36:39], v2, s[48:51], s52 offen
    s_add_u32 s52, s52, 8192
    buffer_load_dwordx4 v[40:43], v2, s[48:51], s52 offen
    s_add_u32 s52, s52, 8192
    buffer_load_dwordx4 v[44:47], v2, s[48:51], s52 offen
    s_add_u32 s52, s52, 8192
    buffer_load_dwordx4 v[48:51], v2, s[48:51], s52 offen
    s_add_u32 s52, s52, 8192
    buffer_load_dwordx4 v[52:55], v2, s[48:51], s52 offen
    s_add_u32 s52, s52, 8192
    buffer_load_dwordx4 v[56:59], v2, s[48:51], s52 offen
    s_add_u32 s52, s52, 8192
    buffer_load_dwordx4 v[60:63], v2, s[48:51], s52 offen
    s_add_u32 s52, s52, 8192
    buffer_load_dwordx4 v[64:67], v2, s[48:51], s52 offen
    s_add_u32 s52, s52, 8192
    buffer_load_dwordx4 v[68:71], v2, s[48:51], s52 offen
    s_add_u32 s52, s52, 8192
    s_waitcnt vmcnt(0)
K1_END:
    s_endpgm
.globl standalone__edge_featured_mpnn_egc__graph_kernel
.p2align 8
.type standalone__edge_featured_mpnn_egc__graph_kernel,@function
standalone__edge_featured_mpnn_egc__graph_kernel:
    s_cmp_ge_u32 s2, 256
    s_cbranch_scc1 K2_END
    s_load_dwordx16 s[4:19], s[0:1], 0
    s_load_dwordx2 s[20:21], s[0:1], 72
    v_bfe_u32 v15, v0, 3, 6
    v_and_b32 v9, 7, v0
    v_lshlrev_b32 v9, 3, v9
    v_lshl_add_u32 v9, v15, 7, v9
    v_lshrrev_b32 v4, 9, v0
    v_lshl_add_u32 v9, v4, 6, v9
    v_lshrrev_b32 v4, 6, v0
    v_and_b32 v1, 63, v0
    v_lshlrev_b32 v8, 4, v0
    v_readfirstlane_b32 s3, v4
    v_and_b32 v6, 31, v1
    v_lshrrev_b32 v7, 5, v1
    s_lshr_b32 s60, s3, 2
    s_and_b32 s61, s3, 3
    s_lshl_b32 s22, s2, 13
    s_waitcnt lgkmcnt(0)
    s_mov_b32 s24, s20
    s_mov_b32 s25, s21
    s_mov_b32 s26, 0x811000
    s_mov_b32 s27, 0x00020000
    buffer_load_dwordx2 v[12:13], v9, s[24:27], s22 offen
    s_mov_b32 s28, s4
    s_mov_b32 s29, s5
    s_mov_b32 s30, 0x271000
    s_mov_b32 s31, 0x00020000
    v_lshrrev_b32 v10, 4, v0
    v_and_b32 v11, 15, v0
    v_lshlrev_b32 v5, 16, v10
    v_lshl_add_u32 v5, v11, 4, v5
    s_lshl_b32 s62, s2, 8
    s_cmp_ge_u32 s3, 10
    s_cbranch_scc1 K2_NOX
    buffer_load_dwordx4 v[32:35], v5, s[28:31], s62 offen
K2_NOX:
    v_lshlrev_b32 v14, 4, v1
    s_lshl_b32 s63, s61, 10
    s_add_u32 s63, s63, 0x810000
    buffer_load_dwordx4 v[76:79], v14, s[24:27], s63 offen
    s_mov_b32 s32, s6
    s_mov_b32 s33, s7
    s_mov_b32 s34, 0x4e2000
    s_mov_b32 s35, 0x00020000
    s_add_u32 s36, s20, 0x200000
    s_addc_u32 s37, s21, 0
    s_mov_b32 s38, 0x4e2000
    s_mov_b32 s39, 0x00020000
    s_mov_b32 s40, s18
    s_mov_b32 s41, s19
    s_mov_b32 s42, 0x271000
    s_mov_b32 s43, 0x00020000
    v_bfe_u32 v16, v0, 0, 1
    v_bfe_u32 v20, v0, 1, 1
    v_lshl_or_b32 v16, v20, 16, v16
    v_mul_u32_u24 v16, 0x3f80, v16
    v_bfe_u32 v17, v0, 2, 1
    v_bfe_u32 v20, v0, 3, 1
    v_lshl_or_b32 v17, v20, 16, v17
    v_mul_u32_u24 v17, 0x3f80, v17
    v_bfe_u32 v18, v0, 4, 1
    v_bfe_u32 v20, v0, 5, 1
    v_lshl_or_b32 v18, v20, 16, v18
    v_mul_u32_u24 v18, 0x3f80, v18
    v_bfe_u32 v19, v0, 6, 1
    v_bfe_u32 v20, v0, 7, 1
    v_lshl_or_b32 v19, v20, 16, v19
    v_mul_u32_u24 v19, 0x3f80, v19
    s_cmp_ge_u32 s3, 4
    s_cbranch_scc1 K2_NOLUT
    ds_write_b128 v8, v[16:19] offset:32768
K2_NOLUT:
    s_lshl_b32 s63, s61, 7
    v_lshlrev_b32 v2, 2, v6
    v_add_u32 v2, s63, v2
    v_mov_b32 v3, v2
    v_mul_u32_u24 v15, 2500, v15
    s_mov_b32 s72, 0
    s_mov_b32 s73, 0
    v_and_b32 v20, 16, v0
    v_cmp_eq_u32 vcc, 0, v20
    v_mov_b32 v21, 0x7ffff000
    v_mov_b32 v28, 0
    v_cndmask_b32 v24, 0, v21, vcc
    v_mov_b32 v29, 0
    v_mov_b32 v30, 0
    v_mov_b32 v31, 0
    v_mov_b32 v25, v24
    v_mov_b32 v26, v24
    v_mov_b32 v27, v24
    v_mov_b32 v20, 36864
    ds_write_b128 v8, v[24:27] offset:0
    ds_write_b128 v8, v[24:27] offset:16384
    ds_write_b128 v20, v[28:31]
    v_add_u32 v21, 96960, v8
    ds_write_b128 v21, v[28:31] offset:0
    ds_write_b128 v21, v[28:31] offset:16384
    ds_write_b128 v21, v[28:31] offset:32768
    s_cmp_ge_u32 s3, 8
    s_cbranch_scc1 K2_NOW
    s_lshl_b32 s63, s3, 13
    s_add_u32 s63, s63, 0x800000
    s_add_u32 s64, s63, 4096
    buffer_load_dwordx4 v[112:115], v14, s[24:27], s63 offen offset:0
    buffer_load_dwordx4 v[116:119], v14, s[24:27], s63 offen offset:1024
    buffer_load_dwordx4 v[120:123], v14, s[24:27], s63 offen offset:2048
    buffer_load_dwordx4 v[124:127], v14, s[24:27], s63 offen offset:3072
    buffer_load_dwordx4 v[56:59], v14, s[24:27], s64 offen offset:0
    buffer_load_dwordx4 v[60:63], v14, s[24:27], s64 offen offset:1024
    buffer_load_dwordx4 v[64:67], v14, s[24:27], s64 offen offset:2048
    buffer_load_dwordx4 v[68:71], v14, s[24:27], s64 offen offset:3072
K2_NOW:
    ds_write_b32 v20, v28 offset:16
    v_mov_b32 v22, 1
    v_mul_u32_u24 v5, 272, v10
    v_lshl_add_u32 v5, v11, 4, v5
    s_mov_b32 s78, 1.0
    s_mov_b32 s79, 1.0
    s_waitcnt lgkmcnt(0)
    s_barrier
    s_cmp_ge_u32 s3, 8
    s_cbranch_scc1 K2_XW1
    s_waitcnt vmcnt(9)
    s_branch K2_XW2
K2_XW1:
    s_waitcnt vmcnt(1)
    s_cmp_ge_u32 s3, 10
    s_cbranch_scc1 K2_B1
K2_XW2:
    ds_write_b128 v5, v[32:35] offset:36928
    s_mov_b64 exec, 1
    ds_add_u32 v20, v22 offset:16
    s_mov_b64 exec, -1
K2_B1:
    v_cmp_eq_u32 vcc, -2, v12
    s_cbranch_vccz K2_COMPACT
    v_mov_b32 v20, 36864
    v_mov_b32 v21, 1
    ds_write_b32 v20, v21 offset:8
K2_COMPACT:
    s_setprio 3
    v_and_b32 v20, 1, v0
    v_lshlrev_b32 v20, 4, v20
    v_mov_b32 v21, 0x7ffff000
    v_cmp_gt_u32 s[74:75], -2, v12
    v_lshrrev_b32 v22, 20, v12
    v_add_lshl_u32 v22, v22, v15, 5
    v_cmp_gt_u32 s[76:77], -2, v13
    v_lshrrev_b32 v23, 20, v13
    v_add_lshl_u32 v23, v23, v15, 5
    v_cndmask_b32 v22, v21, v22, s[74:75]
    v_cndmask_b32 v23, v21, v23, s[76:77]
    s_nop 0
    v_add_u32_dpp v96, v22, v20 quad_perm:[0,0,2,2] row_mask:0xf bank_mask:0xf
    v_add_u32_dpp v100, v22, v20 quad_perm:[1,1,3,3] row_mask:0xf bank_mask:0xf
    v_add_u32_dpp v104, v23, v20 quad_perm:[0,0,2,2] row_mask:0xf bank_mask:0xf
    v_add_u32_dpp v108, v23, v20 quad_perm:[1,1,3,3] row_mask:0xf bank_mask:0xf
    s_cmp_ge_u32 s3, 16
    s_cbranch_scc1 K2_ELATE
    buffer_load_dwordx4 v[96:99], v96, s[32:35], 0 offen
    buffer_load_dwordx4 v[100:103], v100, s[32:35], 0 offen
    buffer_load_dwordx4 v[104:107], v104, s[32:35], 0 offen
    buffer_load_dwordx4 v[108:111], v108, s[32:35], 0 offen
K2_ELATE:
    v_and_b32 v16, 3, v12
    v_lshlrev_b32 v18, 3, v16
    v_bfm_b32 v20, 1, v18
    v_cndmask_b32 v20, 0, v20, s[74:75]
    v_and_b32 v17, 3, v13
    v_lshlrev_b32 v19, 3, v17
    v_bfm_b32 v21, 1, v19
    v_cndmask_b32 v21, 0, v21, s[76:77]
    v_add_u32 v22, v20, v21
    v_mov_b32 v23, v22
    v_bfe_u32 v24, v12, 6, 14
    v_lshlrev_b32 v24, 9, v24
    v_add_u32_dpp v23, v23, v23 row_shr:1 row_mask:0xf bank_mask:0xf bound_ctrl:0
    v_bfe_u32 v28, v12, 2, 4
    v_bfe_u32 v30, v12, 5, 1
    v_add_u32_dpp v23, v23, v23 row_shr:2 row_mask:0xf bank_mask:0xf bound_ctrl:0
    v_and_b32 v25, 3, v28
    v_lshl_or_b32 v25, v30, 2, v25
    v_add_u32_dpp v23, v23, v23 row_shr:4 row_mask:0xf bank_mask:0xf bound_ctrl:0
    v_bfe_u32 v26, v13, 6, 14
    v_lshlrev_b32 v26, 9, v26
    v_add_u32_dpp v23, v23, v23 row_shr:8 row_mask:0xf bank_mask:0xf bound_ctrl:0
    v_bfe_u32 v29, v13, 2, 4
    v_bfe_u32 v31, v13, 5, 1
    v_add_u32_dpp v23, v23, v23 row_bcast:15 row_mask:0xa bank_mask:0xf
    v_and_b32 v27, 3, v29
    v_lshl_or_b32 v27, v31, 2, v27
    v_add_u32_dpp v23, v23, v23 row_bcast:31 row_mask:0xc bank_mask:0xf
    s_nop 0
    v_readlane_b32 s64, v23, 63
    v_sub_u32 v23, v23, v22
    s_and_b32 s65, s64, 0xff
    s_bfe_u32 s66, s64, 0x80008
    s_lshl_b32 s66, s66, 16
    s_or_b32 s65, s65, s66
    s_bfe_u32 s66, s64, 0x80010
    s_lshr_b32 s67, s64, 24
    s_lshl_b32 s67, s67, 16
    s_or_b32 s66, s66, s67
    v_mov_b32 v48, s65
    v_mov_b32 v49, s66
    v_mov_b32 v50, 36864
    s_mov_b64 exec, 1
    ds_add_rtn_u64 v[48:49], v50, v[48:49]
    s_mov_b64 exec, -1
    v_add_u32 v22, v23, v20
    v_bfe_u32 v20, v23, v18, 8
    v_bfe_u32 v21, v22, v19, 8
    v_bfm_b32 v30, 1, v25
    v_bfe_u32 v22, v28, 2, 1
    v_lshlrev_b32 v22, 7, v22
    v_lshlrev_b32 v18, 1, v18
    v_mul_u32_u24 v16, 6144, v16
    v_bfm_b32 v31, 1, v27
    v_bfe_u32 v23, v29, 2, 1
    v_lshlrev_b32 v23, 7, v23
    v_lshlrev_b32 v19, 1, v19
    v_mul_u32_u24 v17, 6144, v17
    s_movk_i32 s68, 384
    s_waitcnt lgkmcnt(0)
    v_readfirstlane_b32 s64, v48
    v_readfirstlane_b32 s65, v49
    s_nop 1
    v_lshrrev_b64 v[48:49], v18, s[64:65]
    v_and_b32 v48, 0xffff, v48
    v_add_u32 v48, v48, v20
    v_cmp_gt_u32 vcc, s68, v48
    v_lshrrev_b32 v49, 5, v48
    v_and_b32 v48, 31, v48
    v_lshl_add_u32 v49, v49, 9, v16
    v_lshl_add_u32 v50, v48, 2, v49
    v_add_u32 v51, v50, v22
    v_lshrrev_b32 v52, 3, v48
    v_and_b32 v53, 3, v48
    v_lshl_or_b32 v52, v52, 2, v53
    v_add_u32 v52, 8, v52
    v_bfm_b32 v52, 1, v52
    v_bfe_u32 v53, v48, 2, 1
    v_lshl_add_u32 v53, v53, 7, v49
    v_lshl_add_u32 v53, v28, 2, v53
    v_bfrev_b32 v12, 1
    v_lshlrev_b32 v48, 4, v48
    s_and_b64 exec, vcc, s[74:75]
    v_lshl_add_u32 v12, v49, 1, v48
    ds_write_b32 v50, v24
    ds_or_b32 v51, v30 offset:256
    ds_or_b32 v53, v52 offset:256
    s_mov_b64 exec, -1
    v_lshrrev_b64 v[48:49], v19, s[64:65]
    v_and_b32 v48, 0xffff, v48
    v_add_u32 v48, v48, v21
    v_cmp_gt_u32 vcc, s68, v48
    v_lshrrev_b32 v49, 5, v48
    v_and_b32 v48, 31, v48
    v_lshl_add_u32 v49, v49, 9, v17
    v_lshl_add_u32 v50, v48, 2, v49
    v_add_u32 v51, v50, v23
    v_lshrrev_b32 v52, 3, v48
    v_and_b32 v53, 3, v48
    v_lshl_or_b32 v52, v52, 2, v53
    v_add_u32 v52, 8, v52
    v_bfm_b32 v52, 1, v52
    v_bfe_u32 v53, v48, 2, 1
    v_lshl_add_u32 v53, v53, 7, v49
    v_lshl_add_u32 v53, v29, 2, v53
    v_bfrev_b32 v13, 1
    v_lshlrev_b32 v48, 4, v48
    s_and_b64 exec, vcc, s[76:77]
    v_lshl_add_u32 v13, v49, 1, v48
    ds_write_b32 v50, v26
    ds_or_b32 v51, v31 offset:256
    ds_or_b32 v53, v52 offset:256
    s_mov_b64 exec, -1
    v_mov_b32 v17, 36864
    v_mov_b32 v16, 0x10000
    s_mov_b64 exec, 1
    ds_add_u32 v17, v16 offset:12
    s_mov_b64 exec, -1
    s_cmp_lt_u32 s3, 16
    s_cbranch_scc1 K2_EEARLY
    buffer_load_dwordx4 v[96:99], v96, s[32:35], 0 offen
    buffer_load_dwordx4 v[100:103], v100, s[32:35], 0 offen
    buffer_load_dwordx4 v[104:107], v104, s[32:35], 0 offen
    buffer_load_dwordx4 v[108:111], v108, s[32:35], 0 offen
K2_EEARLY:
    s_setprio 0
    s_cmp_lg_u32 s72, 0
    s_cbranch_scc1 K2_B2
    s_cmp_ge_u32 s3, 8
    s_cbranch_scc1 K2_B2
    v_and_b32 v9, 15, v1
    v_min_u32 v9, 9, v9
    v_bfe_u32 v73, v1, 4, 1
    v_lshl_add_u32 v9, v9, 2, v73
    v_mul_u32_u24 v9, 272, v9
    v_lshl_add_u32 v9, v7, 4, v9
K2_SPINX:
    ds_read_b32 v16, v17 offset:16
    s_waitcnt lgkmcnt(0)
    v_readfirstlane_b32 s70, v16
    s_cmp_lg_u32 s70, 10
    s_cbranch_scc1 K2_SPINX
    ds_read_b128 v[80:83], v9 offset:36928
    ds_read_b128 v[84:87], v9 offset:37472
    ds_read_b128 v[88:91], v9 offset:36960
    ds_read_b128 v[92:95], v9 offset:37504
    ds_read_b128 v[48:51], v9 offset:36992
    ds_read_b128 v[52:55], v9 offset:37536
    s_waitcnt vmcnt(4)
    ds_read_b128 v[72:75], v9 offset:37024
    s_waitcnt lgkmcnt(6)
    v_mfma_f32_32x32x16_bf16 v[16:31], v[80:83], v[112:115], 0
    ds_read_b128 v[80:83], v9 offset:37568
    s_waitcnt lgkmcnt(6)
    v_mfma_f32_32x32x16_bf16 v[32:47], v[84:87], v[112:115], 0
    ds_read_b128 v[84:87], v9 offset:37056
    s_waitcnt lgkmcnt(6)
    v_mfma_f32_32x32x16_bf16 v[16:31], v[88:91], v[116:119], v[16:31]
    ds_read_b128 v[88:91], v9 offset:37600
    s_waitcnt lgkmcnt(6)
    v_mfma_f32_32x32x16_bf16 v[32:47], v[92:95], v[116:119], v[32:47]
    ds_read_b128 v[92:95], v9 offset:37088
    s_waitcnt lgkmcnt(6)
    v_mfma_f32_32x32x16_bf16 v[16:31], v[48:51], v[120:123], v[16:31]
    ds_read_b128 v[48:51], v9 offset:37632
    s_waitcnt lgkmcnt(6)
    v_mfma_f32_32x32x16_bf16 v[32:47], v[52:55], v[120:123], v[32:47]
    ds_read_b128 v[52:55], v9 offset:37120
    s_waitcnt lgkmcnt(6)
    v_mfma_f32_32x32x16_bf16 v[16:31], v[72:75], v[124:127], v[16:31]
    ds_read_b128 v[72:75], v9 offset:37664
    s_waitcnt lgkmcnt(6)
    v_mfma_f32_32x32x16_bf16 v[32:47], v[80:83], v[124:127], v[32:47]
    ds_read_b128 v[80:83], v9 offset:37152
    s_waitcnt lgkmcnt(6)
    v_mfma_f32_32x32x16_bf16 v[16:31], v[84:87], v[56:59], v[16:31]
    ds_read_b128 v[84:87], v9 offset:37696
    s_waitcnt lgkmcnt(6)
    v_mfma_f32_32x32x16_bf16 v[32:47], v[88:91], v[56:59], v[32:47]
    s_waitcnt lgkmcnt(5)
    v_mfma_f32_32x32x16_bf16 v[16:31], v[92:95], v[60:63], v[16:31]
    s_waitcnt lgkmcnt(4)
    v_mfma_f32_32x32x16_bf16 v[32:47], v[48:51], v[60:63], v[32:47]
    s_waitcnt lgkmcnt(3)
    v_mfma_f32_32x32x16_bf16 v[16:31], v[52:55], v[64:67], v[16:31]
    s_waitcnt lgkmcnt(2)
    v_mfma_f32_32x32x16_bf16 v[32:47], v[72:75], v[64:67], v[32:47]
    s_waitcnt lgkmcnt(1)
    v_mfma_f32_32x32x16_bf16 v[16:31], v[80:83], v[68:71], v[16:31]
    s_waitcnt lgkmcnt(0)
    v_mfma_f32_32x32x16_bf16 v[32:47], v[84:87], v[68:71], v[32:47]
    s_cmp_ge_u32 s3, 4
    s_cbranch_scc1 K2_UOUT
    s_mov_b32 s65, 0xbfb8aa3b
    s_lshl_b32 s70, s61, 10
    v_add_u32 v72, s70, v14
    s_nop 7
    v_mul_f32 v16, s65, v16
    v_mul_f32 v17, s65, v17
    v_mul_f32 v18, s65, v18
    v_mul_f32 v19, s65, v19
    v_mul_f32 v20, s65, v20
    v_mul_f32 v21, s65, v21
    v_mul_f32 v22, s65, v22
    v_mul_f32 v23, s65, v23
    v_mul_f32 v24, s65, v24
    v_mul_f32 v25, s65, v25
    v_mul_f32 v26, s65, v26
    v_mul_f32 v27, s65, v27
    v_mul_f32 v28, s65, v28
    v_mul_f32 v29, s65, v29
    v_mul_f32 v30, s65, v30
    v_mul_f32 v31, s65, v31
    v_mul_f32 v32, s65, v32
    v_mul_f32 v33, s65, v33
    v_mul_f32 v34, s65, v34
    v_mul_f32 v35, s65, v35
    v_mul_f32 v36, s65, v36
    v_mul_f32 v37, s65, v37
    v_mul_f32 v38, s65, v38
    v_mul_f32 v39, s65, v39
    v_mul_f32 v40, s65, v40
    v_mul_f32 v41, s65, v41
    v_mul_f32 v42, s65, v42
    v_mul_f32 v43, s65, v43
    v_mul_f32 v44, s65, v44
    v_mul_f32 v45, s65, v45
    v_mul_f32 v46, s65, v46
    v_mul_f32 v47, s65, v47
    v_cvt_pk_bf16_f32 v16, v16, v17
    v_cvt_pk_bf16_f32 v17, v18, v19
    v_cvt_pk_bf16_f32 v18, v20, v21
    v_cvt_pk_bf16_f32 v19, v22, v23
    v_cvt_pk_bf16_f32 v20, v24, v25
    v_cvt_pk_bf16_f32 v21, v26, v27
    v_cvt_pk_bf16_f32 v22, v28, v29
    v_cvt_pk_bf16_f32 v23, v30, v31
    v_cvt_pk_bf16_f32 v24, v32, v33
    v_cvt_pk_bf16_f32 v25, v34, v35
    v_cvt_pk_bf16_f32 v26, v36, v37
    v_cvt_pk_bf16_f32 v27, v38, v39
    v_cvt_pk_bf16_f32 v28, v40, v41
    v_cvt_pk_bf16_f32 v29, v42, v43
    v_cvt_pk_bf16_f32 v30, v44, v45
    v_cvt_pk_bf16_f32 v31, v46, v47
    ds_write_b128 v72, v[16:19] offset:47808
    ds_write_b128 v72, v[20:23] offset:51904
    ds_write_b128 v72, v[24:27] offset:56000
    ds_write_b128 v72, v[28:31] offset:60096
    s_branch K2_B2
K2_UOUT:
    s_lshl_b32 s70, s61, 11
    s_add_u32 s70, s70, 64192
    v_add_u32 v72, s70, v14
    s_nop 8
    ds_write_b128 v72, v[16:19] offset:0
    ds_write_b128 v72, v[20:23] offset:1024
    ds_write_b128 v72, v[24:27] offset:8192
    ds_write_b128 v72, v[28:31] offset:9216
    ds_write_b128 v72, v[32:35] offset:16384
    ds_write_b128 v72, v[36:39] offset:17408
    ds_write_b128 v72, v[40:43] offset:24576
    ds_write_b128 v72, v[44:47] offset:25600
K2_B2:
    v_mov_b32 v48, 36864
    s_mul_i32 s66, s60, 6144
    v_lshl_add_u32 v4, v7, 4, s66
    v_lshl_add_u32 v5, v1, 2, s66
    s_lshl_b32 s66, s66, 1
    s_add_u32 s66, s66, 96960
    v_add_u32 v10, s66, v14
K2_SPINA:
    ds_read_b128 v[52:55], v48
    s_waitcnt lgkmcnt(0)
    v_readfirstlane_b32 s70, v55
    s_cmp_lt_u32 s70, 0x100000
    s_cbranch_scc1 K2_SPINA
    v_readfirstlane_b32 s64, v52
    v_readfirstlane_b32 s65, v53
    v_readfirstlane_b32 s69, v54
    s_and_b32 s70, s64, 0xffff
    s_lshr_b32 s71, s64, 16
    s_max_u32 s70, s70, s71
    s_and_b32 s71, s65, 0xffff
    s_max_u32 s70, s70, s71
    s_lshr_b32 s71, s65, 16
    s_max_u32 s70, s70, s71
    s_cmp_gt_u32 s70, s68
    s_cselect_b32 s69, 1, s69
    s_cmp_lg_u32 s69, 0
    s_cbranch_scc1 K2_BAD
    s_lshl_b32 s70, s60, 4
    s_lshr_b64 s[64:65], s[64:65], s70
    s_and_b32 s64, s64, 0xffff
    s_add_u32 s64, s64, 31
    s_lshr_b32 s64, s64, 5
    s_setprio 2
    v_and_b32 v16, 1, v0
    v_lshlrev_b32 v16, 9, v16
    v_add_u32 v16, 96960, v16
    v_mov_b32 v17, 36864
    v_add_u32_dpp v18, v12, v16 quad_perm:[0,0,2,2] row_mask:0xf bank_mask:0xf
    v_add_u32_dpp v19, v12, v16 quad_perm:[1,1,3,3] row_mask:0xf bank_mask:0xf
    v_add_u32_dpp v20, v13, v16 quad_perm:[0,0,2,2] row_mask:0xf bank_mask:0xf
    v_add_u32_dpp v21, v13, v16 quad_perm:[1,1,3,3] row_mask:0xf bank_mask:0xf
    v_mov_b32 v16, 1
    s_cmp_lt_u32 s60, 1
    s_cselect_b32 s69, s64, 0
    s_cmp_eq_u32 s69, 0
    s_cbranch_scc1 K2_EW0
K2_I0:
    ds_read_b128 v[48:51], v4 offset:0
    ds_read_b128 v[52:55], v4 offset:32
    s_waitcnt lgkmcnt(1)
    v_lshl_add_u64 v[48:49], v[48:49], 0, v[2:3]
    v_lshl_add_u64 v[50:51], v[50:51], 0, v[2:3]
    buffer_load_dword v80, v48, s[36:39], 0 offen
    buffer_load_dword v81, v49, s[36:39], 0 offen
    buffer_load_dword v82, v50, s[36:39], 0 offen
    buffer_load_dword v83, v51, s[36:39], 0 offen
    s_waitcnt lgkmcnt(0)
    v_lshl_add_u64 v[52:53], v[52:53], 0, v[2:3]
    v_lshl_add_u64 v[54:55], v[54:55], 0, v[2:3]
    buffer_load_dword v84, v52, s[36:39], 0 offen
    buffer_load_dword v85, v53, s[36:39], 0 offen
    buffer_load_dword v86, v54, s[36:39], 0 offen
    buffer_load_dword v87, v55, s[36:39], 0 offen
    ds_read_b128 v[48:51], v4 offset:64
    ds_read_b128 v[52:55], v4 offset:96
    ds_read_b32 v11, v5 offset:256
    s_waitcnt lgkmcnt(2)
    v_lshl_add_u64 v[48:49], v[48:49], 0, v[2:3]
    v_lshl_add_u64 v[50:51], v[50:51], 0, v[2:3]
    buffer_load_dword v88, v48, s[36:39], 0 offen
    buffer_load_dword v89, v49, s[36:39], 0 offen
    buffer_load_dword v90, v50, s[36:39], 0 offen
    buffer_load_dword v91, v51, s[36:39], 0 offen
    s_waitcnt lgkmcnt(1)
    v_lshl_add_u64 v[52:53], v[52:53], 0, v[2:3]
    v_lshl_add_u64 v[54:55], v[54:55], 0, v[2:3]
    buffer_load_dword v92, v52, s[36:39], 0 offen
    buffer_load_dword v93, v53, s[36:39], 0 offen
    buffer_load_dword v94, v54, s[36:39], 0 offen
    buffer_load_dword v95, v55, s[36:39], 0 offen
    v_add_u32 v4, 512, v4
    v_add_u32 v5, 512, v5
    s_cmp_eq_u32 s69, 0
    s_cbranch_scc1 K2_I1
    s_waitcnt vmcnt(16)
    s_branch K2_EW
K2_EW0:
    s_waitcnt vmcnt(0)
K2_EW:
    v_cmpx_le_i32 vcc, 0, v18
    ds_write_b128 v18, v[96:99]
    s_mov_b64 exec, -1
    v_cmpx_le_i32 vcc, 0, v19
    ds_write_b128 v19, v[100:103]
    s_mov_b64 exec, -1
    v_cmpx_le_i32 vcc, 0, v20
    ds_write_b128 v20, v[104:107]
    s_mov_b64 exec, -1
    v_cmpx_le_i32 vcc, 0, v21
    ds_write_b128 v21, v[108:111]
    s_mov_b64 exec, -1
    s_mov_b64 exec, 1
    s_waitcnt lgkmcnt(0)
    ds_add_u32 v17, v16 offset:12
    s_mov_b64 exec, -1
    s_cmp_lg_u32 s69, s64
    s_cbranch_scc1 K2_I0
K2_I1:
    s_cmp_lt_u32 s64, 2
    s_cbranch_scc1 K2_SPIN
    ds_read_b128 v[48:51], v4 offset:0
    ds_read_b128 v[52:55], v4 offset:32
    s_waitcnt lgkmcnt(1)
    v_lshl_add_u64 v[48:49], v[48:49], 0, v[2:3]
    v_lshl_add_u64 v[50:51], v[50:51], 0, v[2:3]
    buffer_load_dword v96, v48, s[36:39], 0 offen
    buffer_load_dword v97, v49, s[36:39], 0 offen
    buffer_load_dword v98, v50, s[36:39], 0 offen
    buffer_load_dword v99, v51, s[36:39], 0 offen
    s_waitcnt lgkmcnt(0)
    v_lshl_add_u64 v[52:53], v[52:53], 0, v[2:3]
    v_lshl_add_u64 v[54:55], v[54:55], 0, v[2:3]
    buffer_load_dword v100, v52, s[36:39], 0 offen
    buffer_load_dword v101, v53, s[36:39], 0 offen
    buffer_load_dword v102, v54, s[36:39], 0 offen
    buffer_load_dword v103, v55, s[36:39], 0 offen
    ds_read_b128 v[48:51], v4 offset:64
    ds_read_b128 v[52:55], v4 offset:96
    ds_read_b32 v12, v5 offset:256
    s_waitcnt lgkmcnt(2)
    v_lshl_add_u64 v[48:49], v[48:49], 0, v[2:3]
    v_lshl_add_u64 v[50:51], v[50:51], 0, v[2:3]
    buffer_load_dword v104, v48, s[36:39], 0 offen
    buffer_load_dword v105, v49, s[36:39], 0 offen
    buffer_load_dword v106, v50, s[36:39], 0 offen
    buffer_load_dword v107, v51, s[36:39], 0 offen
    s_waitcnt lgkmcnt(1)
    v_lshl_add_u64 v[52:53], v[52:53], 0, v[2:3]
    v_lshl_add_u64 v[54:55], v[54:55], 0, v[2:3]
    buffer_load_dword v108, v52, s[36:39], 0 offen
    buffer_load_dword v109, v53, s[36:39], 0 offen
    buffer_load_dword v110, v54, s[36:39], 0 offen
    buffer_load_dword v111, v55, s[36:39], 0 offen
    v_add_u32 v4, 512, v4
    v_add_u32 v5, 512, v5
K2_SPIN:
K2_SPINE:
    ds_read_b32 v16, v17 offset:12
    s_waitcnt lgkmcnt(0)
    v_readfirstlane_b32 s70, v16
    s_cmp_lg_u32 s70, 0x100010
    s_cbranch_scc1 K2_SPINE
    s_cmp_lg_u32 s73, 0
    s_cbranch_scc1 K2_LOOP0
    s_mov_b32 s73, 1
    s_lshl_b32 s70, s3, 10
    v_add_u32 v18, s70, v14
    ds_read_b128 v[72:75], v18 offset:47808
    s_lshl_b32 s70, s3, 11
    s_add_u32 s70, s70, 64192
    v_add_u32 v18, s70, v14
    ds_read_b128 v[32:35], v18
    ds_read_b128 v[36:39], v18 offset:1024
    v_mov_b32 v40, 0
    v_mov_b32 v41, 0
    v_mov_b32 v42, 0
    v_mov_b32 v43, 0
    v_mov_b32 v44, 0
    v_mov_b32 v45, 0
    v_mov_b32 v46, 0
    v_mov_b32 v47, 0
K2_LOOP0:
    s_cmp_eq_u32 s64, 0
    s_cbranch_scc1 K2_BATCH_DONE
    ds_read_b128 v[68:71], v10
    v_lshlrev_b32_sdwa v9, 4, v11 dst_sel:DWORD dst_unused:UNUSED_PAD src0_sel:DWORD src1_sel:BYTE_0
    ds_read_b128 v[56:59], v9 offset:32768
    v_lshlrev_b32_sdwa v9, 4, v11 dst_sel:DWORD dst_unused:UNUSED_PAD src0_sel:DWORD src1_sel:BYTE_1
    ds_read_b128 v[60:63], v9 offset:32768
    v_lshlrev_b32_sdwa v9, 4, v11 dst_sel:DWORD dst_unused:UNUSED_PAD src0_sel:DWORD src1_sel:BYTE_2
    ds_read_b128 v[64:67], v9 offset:32768
    ds_read_b128 v[48:51], v4 offset:0
    ds_read_b128 v[52:55], v4 offset:32
    v_add_u32 v10, 1024, v10
    s_cmp_eq_u32 s64, 1
    s_cbranch_scc1 K2_W0
    s_waitcnt vmcnt(16)
K2_C0:
    v_lshlrev_b64 v[16:17], 16, v[80:81]
    v_lshlrev_b64 v[18:19], 16, v[82:83]
    v_lshlrev_b64 v[20:21], 16, v[84:85]
    v_lshlrev_b64 v[22:23], 16, v[86:87]
    v_lshlrev_b64 v[24:25], 16, v[88:89]
    v_lshlrev_b64 v[26:27], 16, v[90:91]
    v_lshlrev_b64 v[28:29], 16, v[92:93]
    v_lshlrev_b64 v[30:31], 16, v[94:95]
    s_sub_u32 s64, s64, 1
    s_waitcnt lgkmcnt(0)
    v_mfma_f32_32x32x16_bf16 v[16:31], v[68:71], v[76:79], v[16:31]
    v_mfma_f32_32x32x16_bf16 v[16:31], v[56:59], v[72:75], v[16:31]
    s_cmp_lt_u32 s64, 2
    s_cbranch_scc1 K2_N0
    v_lshl_add_u64 v[48:49], v[48:49], 0, v[2:3]
    v_lshl_add_u64 v[50:51], v[50:51], 0, v[2:3]
    buffer_load_dword v112, v48, s[36:39], 0 offen
    buffer_load_dword v113, v49, s[36:39], 0 offen
    buffer_load_dword v114, v50, s[36:39], 0 offen
    buffer_load_dword v115, v51, s[36:39], 0 offen
    v_lshl_add_u64 v[52:53], v[52:53], 0, v[2:3]
    v_lshl_add_u64 v[54:55], v[54:55], 0, v[2:3]
    buffer_load_dword v116, v52, s[36:39], 0 offen
    buffer_load_dword v117, v53, s[36:39], 0 offen
    buffer_load_dword v118, v54, s[36:39], 0 offen
    buffer_load_dword v119, v55, s[36:39], 0 offen
    ds_read_b128 v[48:51], v4 offset:64
    ds_read_b128 v[52:55], v4 offset:96
    ds_read_b32 v13, v5 offset:256
    s_waitcnt lgkmcnt(2)
    v_lshl_add_u64 v[48:49], v[48:49], 0, v[2:3]
    v_lshl_add_u64 v[50:51], v[50:51], 0, v[2:3]
    buffer_load_dword v120, v48, s[36:39], 0 offen
    buffer_load_dword v121, v49, s[36:39], 0 offen
    buffer_load_dword v122, v50, s[36:39], 0 offen
    buffer_load_dword v123, v51, s[36:39], 0 offen
    s_waitcnt lgkmcnt(1)
    v_lshl_add_u64 v[52:53], v[52:53], 0, v[2:3]
    v_lshl_add_u64 v[54:55], v[54:55], 0, v[2:3]
    buffer_load_dword v124, v52, s[36:39], 0 offen
    buffer_load_dword v125, v53, s[36:39], 0 offen
    buffer_load_dword v126, v54, s[36:39], 0 offen
    buffer_load_dword v127, v55, s[36:39], 0 offen
    v_add_u32 v4, 512, v4
    v_add_u32 v5, 512, v5
K2_X0:
    v_exp_f32 v16, v16
    v_exp_f32 v17, v17
    v_exp_f32 v18, v18
    v_exp_f32 v19, v19
    v_exp_f32 v20, v20
    v_exp_f32 v21, v21
    v_exp_f32 v22, v22
    v_exp_f32 v23, v23
    v_exp_f32 v24, v24
    v_exp_f32 v25, v25
    v_exp_f32 v26, v26
    v_exp_f32 v27, v27
    v_exp_f32 v28, v28
    v_exp_f32 v29, v29
    v_exp_f32 v30, v30
    v_exp_f32 v31, v31
    v_pk_add_f32 v[16:17], v[16:17], s[78:79]
    v_pk_add_f32 v[18:19], v[18:19], s[78:79]
    v_pk_add_f32 v[20:21], v[20:21], s[78:79]
    v_pk_add_f32 v[22:23], v[22:23], s[78:79]
    v_pk_add_f32 v[24:25], v[24:25], s[78:79]
    v_pk_add_f32 v[26:27], v[26:27], s[78:79]
    v_pk_add_f32 v[28:29], v[28:29], s[78:79]
    v_pk_add_f32 v[30:31], v[30:31], s[78:79]
    v_rcp_f32 v16, v16
    v_rcp_f32 v17, v17
    v_rcp_f32 v18, v18
    v_rcp_f32 v19, v19
    v_rcp_f32 v20, v20
    v_rcp_f32 v21, v21
    v_rcp_f32 v22, v22
    v_rcp_f32 v23, v23
    v_rcp_f32 v24, v24
    v_rcp_f32 v25, v25
    v_rcp_f32 v26, v26
    v_rcp_f32 v27, v27
    v_rcp_f32 v28, v28
    v_rcp_f32 v29, v29
    v_rcp_f32 v30, v30
    v_rcp_f32 v31, v31
    v_pk_mul_f32 v[16:17], v[16:17], v[80:81]
    v_pk_mul_f32 v[18:19], v[18:19], v[82:83]
    v_pk_mul_f32 v[20:21], v[20:21], v[84:85]
    v_pk_mul_f32 v[22:23], v[22:23], v[86:87]
    v_pk_mul_f32 v[24:25], v[24:25], v[88:89]
    v_pk_mul_f32 v[26:27], v[26:27], v[90:91]
    v_pk_mul_f32 v[28:29], v[28:29], v[92:93]
    v_pk_mul_f32 v[30:31], v[30:31], v[94:95]
    v_cvt_pk_bf16_f32 v16, v16, v17
    v_cvt_pk_bf16_f32 v17, v18, v19
    v_cvt_pk_bf16_f32 v18, v20, v21
    v_cvt_pk_bf16_f32 v19, v22, v23
    v_cvt_pk_bf16_f32 v20, v24, v25
    v_cvt_pk_bf16_f32 v21, v26, v27
    v_cvt_pk_bf16_f32 v22, v28, v29
    v_cvt_pk_bf16_f32 v23, v30, v31
    s_waitcnt lgkmcnt(0)
    s_nop 0
    v_mfma_f32_32x32x16_bf16 v[32:47], v[60:63], v[16:19], v[32:47]
    v_mfma_f32_32x32x16_bf16 v[32:47], v[64:67], v[20:23], v[32:47]
    s_cmp_gt_u32 s64, 3
    s_cbranch_scc1 K2_PR0
    s_setprio 1
    s_cmp_gt_u32 s64, 1
    s_cbranch_scc1 K2_PR0
    s_setprio 0
K2_PR0:
K2_LOOP1:
    s_cmp_eq_u32 s64, 0
    s_cbranch_scc1 K2_BATCH_DONE
    ds_read_b128 v[68:71], v10
    v_lshlrev_b32_sdwa v9, 4, v12 dst_sel:DWORD dst_unused:UNUSED_PAD src0_sel:DWORD src1_sel:BYTE_0
    ds_read_b128 v[56:59], v9 offset:32768
    v_lshlrev_b32_sdwa v9, 4, v12 dst_sel:DWORD dst_unused:UNUSED_PAD src0_sel:DWORD src1_sel:BYTE_1
    ds_read_b128 v[60:63], v9 offset:32768
    v_lshlrev_b32_sdwa v9, 4, v12 dst_sel:DWORD dst_unused:UNUSED_PAD src0_sel:DWORD src1_sel:BYTE_2
    ds_read_b128 v[64:67], v9 offset:32768
    ds_read_b128 v[48:51], v4 offset:0
    ds_read_b128 v[52:55], v4 offset:32
    v_add_u32 v10, 1024, v10
    s_cmp_eq_u32 s64, 1
    s_cbranch_scc1 K2_W1
    s_waitcnt vmcnt(16)
K2_C1:
    v_lshlrev_b64 v[16:17], 16, v[96:97]
    v_lshlrev_b64 v[18:19], 16, v[98:99]
    v_lshlrev_b64 v[20:21], 16, v[100:101]
    v_lshlrev_b64 v[22:23], 16, v[102:103]
    v_lshlrev_b64 v[24:25], 16, v[104:105]
    v_lshlrev_b64 v[26:27], 16, v[106:107]
    v_lshlrev_b64 v[28:29], 16, v[108:109]
    v_lshlrev_b64 v[30:31], 16, v[110:111]
    s_sub_u32 s64, s64, 1
    s_waitcnt lgkmcnt(0)
    v_mfma_f32_32x32x16_bf16 v[16:31], v[68:71], v[76:79], v[16:31]
    v_mfma_f32_32x32x16_bf16 v[16:31], v[56:59], v[72:75], v[16:31]
    s_cmp_lt_u32 s64, 2
    s_cbranch_scc1 K2_N1
    v_lshl_add_u64 v[48:49], v[48:49], 0, v[2:3]
    v_lshl_add_u64 v[50:51], v[50:51], 0, v[2:3]
    buffer_load_dword v80, v48, s[36:39], 0 offen
    buffer_load_dword v81, v49, s[36:39], 0 offen
    buffer_load_dword v82, v50, s[36:39], 0 offen
    buffer_load_dword v83, v51, s[36:39], 0 offen
    v_lshl_add_u64 v[52:53], v[52:53], 0, v[2:3]
    v_lshl_add_u64 v[54:55], v[54:55], 0, v[2:3]
    buffer_load_dword v84, v52, s[36:39], 0 offen
    buffer_load_dword v85, v53, s[36:39], 0 offen
    buffer_load_dword v86, v54, s[36:39], 0 offen
    buffer_load_dword v87, v55, s[36:39], 0 offen
    ds_read_b128 v[48:51], v4 offset:64
    ds_read_b128 v[52:55], v4 offset:96
    ds_read_b32 v11, v5 offset:256
    s_waitcnt lgkmcnt(2)
    v_lshl_add_u64 v[48:49], v[48:49], 0, v[2:3]
    v_lshl_add_u64 v[50:51], v[50:51], 0, v[2:3]
    buffer_load_dword v88, v48, s[36:39], 0 offen
    buffer_load_dword v89, v49, s[36:39], 0 offen
    buffer_load_dword v90, v50, s[36:39], 0 offen
    buffer_load_dword v91, v51, s[36:39], 0 offen
    s_waitcnt lgkmcnt(1)
    v_lshl_add_u64 v[52:53], v[52:53], 0, v[2:3]
    v_lshl_add_u64 v[54:55], v[54:55], 0, v[2:3]
    buffer_load_dword v92, v52, s[36:39], 0 offen
    buffer_load_dword v93, v53, s[36:39], 0 offen
    buffer_load_dword v94, v54, s[36:39], 0 offen
    buffer_load_dword v95, v55, s[36:39], 0 offen
    v_add_u32 v4, 512, v4
    v_add_u32 v5, 512, v5
K2_X1:
    v_exp_f32 v16, v16
    v_exp_f32 v17, v17
    v_exp_f32 v18, v18
    v_exp_f32 v19, v19
    v_exp_f32 v20, v20
    v_exp_f32 v21, v21
    v_exp_f32 v22, v22
    v_exp_f32 v23, v23
    v_exp_f32 v24, v24
    v_exp_f32 v25, v25
    v_exp_f32 v26, v26
    v_exp_f32 v27, v27
    v_exp_f32 v28, v28
    v_exp_f32 v29, v29
    v_exp_f32 v30, v30
    v_exp_f32 v31, v31
    v_pk_add_f32 v[16:17], v[16:17], s[78:79]
    v_pk_add_f32 v[18:19], v[18:19], s[78:79]
    v_pk_add_f32 v[20:21], v[20:21], s[78:79]
    v_pk_add_f32 v[22:23], v[22:23], s[78:79]
    v_pk_add_f32 v[24:25], v[24:25], s[78:79]
    v_pk_add_f32 v[26:27], v[26:27], s[78:79]
    v_pk_add_f32 v[28:29], v[28:29], s[78:79]
    v_pk_add_f32 v[30:31], v[30:31], s[78:79]
    v_rcp_f32 v16, v16
    v_rcp_f32 v17, v17
    v_rcp_f32 v18, v18
    v_rcp_f32 v19, v19
    v_rcp_f32 v20, v20
    v_rcp_f32 v21, v21
    v_rcp_f32 v22, v22
    v_rcp_f32 v23, v23
    v_rcp_f32 v24, v24
    v_rcp_f32 v25, v25
    v_rcp_f32 v26, v26
    v_rcp_f32 v27, v27
    v_rcp_f32 v28, v28
    v_rcp_f32 v29, v29
    v_rcp_f32 v30, v30
    v_rcp_f32 v31, v31
    v_pk_mul_f32 v[16:17], v[16:17], v[96:97]
    v_pk_mul_f32 v[18:19], v[18:19], v[98:99]
    v_pk_mul_f32 v[20:21], v[20:21], v[100:101]
    v_pk_mul_f32 v[22:23], v[22:23], v[102:103]
    v_pk_mul_f32 v[24:25], v[24:25], v[104:105]
    v_pk_mul_f32 v[26:27], v[26:27], v[106:107]
    v_pk_mul_f32 v[28:29], v[28:29], v[108:109]
    v_pk_mul_f32 v[30:31], v[30:31], v[110:111]
    v_cvt_pk_bf16_f32 v16, v16, v17
    v_cvt_pk_bf16_f32 v17, v18, v19
    v_cvt_pk_bf16_f32 v18, v20, v21
    v_cvt_pk_bf16_f32 v19, v22, v23
    v_cvt_pk_bf16_f32 v20, v24, v25
    v_cvt_pk_bf16_f32 v21, v26, v27
    v_cvt_pk_bf16_f32 v22, v28, v29
    v_cvt_pk_bf16_f32 v23, v30, v31
    s_waitcnt lgkmcnt(0)
    s_nop 0
    v_mfma_f32_32x32x16_bf16 v[32:47], v[60:63], v[16:19], v[32:47]
    v_mfma_f32_32x32x16_bf16 v[32:47], v[64:67], v[20:23], v[32:47]
    s_cmp_gt_u32 s64, 3
    s_cbranch_scc1 K2_PR1
    s_setprio 1
    s_cmp_gt_u32 s64, 1
    s_cbranch_scc1 K2_PR1
    s_setprio 0
K2_PR1:
K2_LOOP2:
    s_cmp_eq_u32 s64, 0
    s_cbranch_scc1 K2_BATCH_DONE
    ds_read_b128 v[68:71], v10
    v_lshlrev_b32_sdwa v9, 4, v13 dst_sel:DWORD dst_unused:UNUSED_PAD src0_sel:DWORD src1_sel:BYTE_0
    ds_read_b128 v[56:59], v9 offset:32768
    v_lshlrev_b32_sdwa v9, 4, v13 dst_sel:DWORD dst_unused:UNUSED_PAD src0_sel:DWORD src1_sel:BYTE_1
    ds_read_b128 v[60:63], v9 offset:32768
    v_lshlrev_b32_sdwa v9, 4, v13 dst_sel:DWORD dst_unused:UNUSED_PAD src0_sel:DWORD src1_sel:BYTE_2
    ds_read_b128 v[64:67], v9 offset:32768
    ds_read_b128 v[48:51], v4 offset:0
    ds_read_b128 v[52:55], v4 offset:32
    v_add_u32 v10, 1024, v10
    s_cmp_eq_u32 s64, 1
    s_cbranch_scc1 K2_W2
    s_waitcnt vmcnt(16)
K2_C2:
    v_lshlrev_b64 v[16:17], 16, v[112:113]
    v_lshlrev_b64 v[18:19], 16, v[114:115]
    v_lshlrev_b64 v[20:21], 16, v[116:117]
    v_lshlrev_b64 v[22:23], 16, v[118:119]
    v_lshlrev_b64 v[24:25], 16, v[120:121]
    v_lshlrev_b64 v[26:27], 16, v[122:123]
    v_lshlrev_b64 v[28:29], 16, v[124:125]
    v_lshlrev_b64 v[30:31], 16, v[126:127]
    s_sub_u32 s64, s64, 1
    s_waitcnt lgkmcnt(0)
    v_mfma_f32_32x32x16_bf16 v[16:31], v[68:71], v[76:79], v[16:31]
    v_mfma_f32_32x32x16_bf16 v[16:31], v[56:59], v[72:75], v[16:31]
    s_cmp_lt_u32 s64, 2
    s_cbranch_scc1 K2_N2
    v_lshl_add_u64 v[48:49], v[48:49], 0, v[2:3]
    v_lshl_add_u64 v[50:51], v[50:51], 0, v[2:3]
    buffer_load_dword v96, v48, s[36:39], 0 offen
    buffer_load_dword v97, v49, s[36:39], 0 offen
    buffer_load_dword v98, v50, s[36:39], 0 offen
    buffer_load_dword v99, v51, s[36:39], 0 offen
    v_lshl_add_u64 v[52:53], v[52:53], 0, v[2:3]
    v_lshl_add_u64 v[54:55], v[54:55], 0, v[2:3]
    buffer_load_dword v100, v52, s[36:39], 0 offen
    buffer_load_dword v101, v53, s[36:39], 0 offen
    buffer_load_dword v102, v54, s[36:39], 0 offen
    buffer_load_dword v103, v55, s[36:39], 0 offen
    ds_read_b128 v[48:51], v4 offset:64
    ds_read_b128 v[52:55], v4 offset:96
    ds_read_b32 v12, v5 offset:256
    s_waitcnt lgkmcnt(2)
    v_lshl_add_u64 v[48:49], v[48:49], 0, v[2:3]
    v_lshl_add_u64 v[50:51], v[50:51], 0, v[2:3]
    buffer_load_dword v104, v48, s[36:39], 0 offen
    buffer_load_dword v105, v49, s[36:39], 0 offen
    buffer_load_dword v106, v50, s[36:39], 0 offen
    buffer_load_dword v107, v51, s[36:39], 0 offen
    s_waitcnt lgkmcnt(1)
    v_lshl_add_u64 v[52:53], v[52:53], 0, v[2:3]
    v_lshl_add_u64 v[54:55], v[54:55], 0, v[2:3]
    buffer_load_dword v108, v52, s[36:39], 0 offen
    buffer_load_dword v109, v53, s[36:39], 0 offen
    buffer_load_dword v110, v54, s[36:39], 0 offen
    buffer_load_dword v111, v55, s[36:39], 0 offen
    v_add_u32 v4, 512, v4
    v_add_u32 v5, 512, v5
K2_X2:
    v_exp_f32 v16, v16
    v_exp_f32 v17, v17
    v_exp_f32 v18, v18
    v_exp_f32 v19, v19
    v_exp_f32 v20, v20
    v_exp_f32 v21, v21
    v_exp_f32 v22, v22
    v_exp_f32 v23, v23
    v_exp_f32 v24, v24
    v_exp_f32 v25, v25
    v_exp_f32 v26, v26
    v_exp_f32 v27, v27
    v_exp_f32 v28, v28
    v_exp_f32 v29, v29
    v_exp_f32 v30, v30
    v_exp_f32 v31, v31
    v_pk_add_f32 v[16:17], v[16:17], s[78:79]
    v_pk_add_f32 v[18:19], v[18:19], s[78:79]
    v_pk_add_f32 v[20:21], v[20:21], s[78:79]
    v_pk_add_f32 v[22:23], v[22:23], s[78:79]
    v_pk_add_f32 v[24:25], v[24:25], s[78:79]
    v_pk_add_f32 v[26:27], v[26:27], s[78:79]
    v_pk_add_f32 v[28:29], v[28:29], s[78:79]
    v_pk_add_f32 v[30:31], v[30:31], s[78:79]
    v_rcp_f32 v16, v16
    v_rcp_f32 v17, v17
    v_rcp_f32 v18, v18
    v_rcp_f32 v19, v19
    v_rcp_f32 v20, v20
    v_rcp_f32 v21, v21
    v_rcp_f32 v22, v22
    v_rcp_f32 v23, v23
    v_rcp_f32 v24, v24
    v_rcp_f32 v25, v25
    v_rcp_f32 v26, v26
    v_rcp_f32 v27, v27
    v_rcp_f32 v28, v28
    v_rcp_f32 v29, v29
    v_rcp_f32 v30, v30
    v_rcp_f32 v31, v31
    v_pk_mul_f32 v[16:17], v[16:17], v[112:113]
    v_pk_mul_f32 v[18:19], v[18:19], v[114:115]
    v_pk_mul_f32 v[20:21], v[20:21], v[116:117]
    v_pk_mul_f32 v[22:23], v[22:23], v[118:119]
    v_pk_mul_f32 v[24:25], v[24:25], v[120:121]
    v_pk_mul_f32 v[26:27], v[26:27], v[122:123]
    v_pk_mul_f32 v[28:29], v[28:29], v[124:125]
    v_pk_mul_f32 v[30:31], v[30:31], v[126:127]
    v_cvt_pk_bf16_f32 v16, v16, v17
    v_cvt_pk_bf16_f32 v17, v18, v19
    v_cvt_pk_bf16_f32 v18, v20, v21
    v_cvt_pk_bf16_f32 v19, v22, v23
    v_cvt_pk_bf16_f32 v20, v24, v25
    v_cvt_pk_bf16_f32 v21, v26, v27
    v_cvt_pk_bf16_f32 v22, v28, v29
    v_cvt_pk_bf16_f32 v23, v30, v31
    s_waitcnt lgkmcnt(0)
    s_nop 0
    v_mfma_f32_32x32x16_bf16 v[32:47], v[60:63], v[16:19], v[32:47]
    v_mfma_f32_32x32x16_bf16 v[32:47], v[64:67], v[20:23], v[32:47]
    s_cmp_gt_u32 s64, 3
    s_cbranch_scc1 K2_PR2
    s_setprio 1
    s_cmp_gt_u32 s64, 1
    s_cbranch_scc1 K2_PR2
    s_setprio 0
K2_PR2:
    s_branch K2_LOOP0
K2_W0:
    s_waitcnt vmcnt(0)
    s_branch K2_C0
K2_N0:
    s_nop 10
    s_branch K2_X0
K2_W1:
    s_waitcnt vmcnt(0)
    s_branch K2_C1
K2_N1:
    s_nop 10
    s_branch K2_X1
K2_W2:
    s_waitcnt vmcnt(0)
    s_branch K2_C2
K2_N2:
    s_nop 10
    s_branch K2_X2
K2_BAD:
    s_cmp_eq_u32 s72, 0
    s_cselect_b32 s58, 0, s58
    s_movk_i32 s59, 2048
    s_cselect_b32 s59, s59, 256
    s_mov_b32 s72, 1
    s_branch K2_SCAN
K2_BATCH_DONE:
    s_cmp_eq_u32 s72, 0
    s_cbranch_scc1 K2_EPI
    s_add_u32 s58, s58, s59
    s_movk_i32 s59, 2048
    s_cmp_ge_u32 s58, 160000
    s_cbranch_scc1 K2_EPI
K2_SCAN:
    s_waitcnt vmcnt(0) lgkmcnt(0)
    s_mov_b32 s44, s8
    s_mov_b32 s45, s9
    s_mov_b32 s46, 0x9c400
    s_mov_b32 s47, 0x00020000
    s_mov_b32 s48, s10
    s_mov_b32 s49, s11
    s_mov_b32 s50, 0x9c400
    s_mov_b32 s51, 0x00020000
    s_lshl_b32 s57, s58, 2
    v_lshlrev_b32 v9, 3, v0
    buffer_load_dwordx2 v[48:49], v9, s[48:51], s57 offen
    buffer_load_dwordx2 v[50:51], v9, s[44:47], s57 offen
    s_barrier
    v_and_b32 v20, 16, v0
    v_cmp_eq_u32 vcc, 0, v20
    v_mov_b32 v21, 0x7ffff000
    v_mov_b32 v28, 0
    v_cndmask_b32 v24, 0, v21, vcc
    v_mov_b32 v29, 0
    v_mov_b32 v30, 0
    v_mov_b32 v31, 0
    v_mov_b32 v25, v24
    v_mov_b32 v26, v24
    v_mov_b32 v27, v24
    v_mov_b32 v20, 36864
    ds_write_b128 v8, v[24:27] offset:0
    ds_write_b128 v8, v[24:27] offset:16384
    ds_write_b128 v20, v[28:31]
    v_add_u32 v21, 96960, v8
    ds_write_b128 v21, v[28:31] offset:0
    ds_write_b128 v21, v[28:31] offset:16384
    ds_write_b128 v21, v[28:31] offset:32768
    v_mov_b32 v15, s58
    s_sub_u32 s57, 160000, s58
    s_min_u32 s57, s57, s59
    s_waitcnt vmcnt(0)
    v_lshl_add_u32 v20, v0, 1, 0
    v_and_b32 v21, 0xff, v48
    v_cmp_eq_u32 vcc, s2, v21
    v_cmp_gt_u32 s[66:67], s57, v20
    s_and_b64 vcc, vcc, s[66:67]
    v_lshrrev_b32 v21, 8, v48
    v_lshl_or_b32 v21, v50, 6, v21
    v_lshl_or_b32 v21, v20, 20, v21
    v_cndmask_b32 v12, -1, v21, vcc
    v_lshl_add_u32 v20, v0, 1, 1
    v_and_b32 v21, 0xff, v49
    v_cmp_eq_u32 vcc, s2, v21
    v_cmp_gt_u32 s[66:67], s57, v20
    s_and_b64 vcc, vcc, s[66:67]
    v_lshrrev_b32 v21, 8, v49
    v_lshl_or_b32 v21, v51, 6, v21
    v_lshl_or_b32 v21, v20, 20, v21
    v_cndmask_b32 v13, -1, v21, vcc
    s_waitcnt lgkmcnt(0)
    s_barrier
    s_branch K2_COMPACT
K2_EPI:
    s_waitcnt vmcnt(0) lgkmcnt(0)
    s_mov_b32 s65, 0xbfb8aa3b
    v_lshlrev_b32 v9, 20, v7
    v_lshl_add_u32 v9, v6, 1, v9
    s_lshl_b32 s63, s61, 6
    s_add_u32 s62, s62, s63
    s_lshl_b32 s63, s60, 16
    s_add_u32 s62, s62, s63
    s_nop 7
    v_mul_f32 v16, s65, v32
    v_mul_f32 v17, s65, v33
    v_mul_f32 v18, s65, v34
    v_mul_f32 v19, s65, v35
    v_mul_f32 v20, s65, v36
    v_mul_f32 v21, s65, v37
    v_exp_f32 v16, v16
    v_exp_f32 v17, v17
    v_exp_f32 v18, v18
    v_exp_f32 v19, v19
    v_exp_f32 v20, v20
    v_exp_f32 v21, v21
    v_add_f32 v16, 1.0, v16
    v_add_f32 v17, 1.0, v17
    v_add_f32 v18, 1.0, v18
    v_add_f32 v19, 1.0, v19
    v_add_f32 v20, 1.0, v20
    v_add_f32 v21, 1.0, v21
    v_rcp_f32 v16, v16
    v_rcp_f32 v17, v17
    v_rcp_f32 v18, v18
    v_rcp_f32 v19, v19
    v_rcp_f32 v20, v20
    v_rcp_f32 v21, v21
    v_mul_f32 v16, v16, v32
    v_mul_f32 v17, v17, v33
    v_mul_f32 v18, v18, v34
    v_mul_f32 v19, v19, v35
    v_mul_f32 v20, v20, v36
    v_mul_f32 v21, v21, v37
    v_cvt_pk_bf16_f32 v16, v16, v16
    v_cvt_pk_bf16_f32 v17, v17, v17
    v_cvt_pk_bf16_f32 v18, v18, v18
    v_cvt_pk_bf16_f32 v19, v19, v19
    v_cvt_pk_bf16_f32 v20, v20, v20
    v_cvt_pk_bf16_f32 v21, v21, v21
    s_add_u32 s63, s62, 0
    buffer_store_short v16, v9, s[40:43], s63 offen sc1 nt
    s_add_u32 s63, s62, 262144
    buffer_store_short v17, v9, s[40:43], s63 offen sc1 nt
    s_add_u32 s63, s62, 524288
    buffer_store_short v18, v9, s[40:43], s63 offen sc1 nt
    s_add_u32 s63, s62, 786432
    buffer_store_short v19, v9, s[40:43], s63 offen sc1 nt
    s_mov_b32 exec_hi, 0
    s_add_u32 s63, s62, 2097152
    buffer_store_short v20, v9, s[40:43], s63 offen sc1 nt
    s_add_u32 s63, s62, 2359296
    buffer_store_short v21, v9, s[40:43], s63 offen sc1 nt
K2_END:
    s_endpgm
.section .rodata,"a"
.p2align 6
.amdhsa_kernel prep_kernel
  .amdhsa_next_free_vgpr 176
  .amdhsa_next_free_sgpr 56
  .amdhsa_accum_offset 176
  .amdhsa_group_segment_fixed_size 0
  .amdhsa_kernarg_size 80
  .amdhsa_user_sgpr_count 2
  .amdhsa_user_sgpr_kernarg_segment_ptr 1
  .amdhsa_system_sgpr_workgroup_id_x 1
.end_amdhsa_kernel
.p2align 6
.amdhsa_kernel standalone__edge_featured_mpnn_egc__graph_kernel
  .amdhsa_next_free_vgpr 128
  .amdhsa_next_free_sgpr 80
  .amdhsa_accum_offset 128
  .amdhsa_group_segment_fixed_size 0
  .amdhsa_kernarg_size 80
  .amdhsa_user_sgpr_count 2
  .amdhsa_user_sgpr_kernarg_segment_ptr 1
  .amdhsa_system_sgpr_workgroup_id_x 1
.end_amdhsa_kernel
```
